```python
import torch

def _softmax(x, axis=-1):
    return torch.softmax(x, dim=axis)
def _gelu(x):
    return torch.nn.functional.gelu(x, approximate="tanh")
def _silu(x):
    return torch.nn.functional.silu(x)
def _sigmoid(x):
    return torch.sigmoid(x)
def _layernorm(x, axis=-1, eps=1e-5):
    m = x.mean(dim=axis, keepdim=True)
    v = x.var(dim=axis, keepdim=True, unbiased=False)
    return (x - m) / torch.sqrt(v + eps)
def _scatter_add(tgt, idx, src, axis=0):
    return tgt.clone().index_add_(axis, idx, src)
def _segment_sum(src, seg, n):
    out = torch.zeros((n,) + src.shape[1:], dtype=src.dtype)
    return out.index_add_(0, seg, src)
def _pad(x, pw):
    flat = tuple(v for pair in reversed(pw) for v in pair)
    return torch.nn.functional.pad(x, flat)

kernel_name = 'concat_heads__gqa_block_cached__gqa_block_cached__near_ridge'

def setup_inputs():

    _w = (lambda a: (lambda t: t.to(torch.bfloat16) if t.is_floating_point() else t)(torch.as_tensor(a)))
    def _A_setup():
        B, Sq, D = 32, 64, 576
        Hq, Hkv, Sk, Dh = 32, 16, 512, 128
        assert Hq % Hkv == 0, (Hq, Hkv)
        return {
            "x": _w((lambda *s: torch.randn(*s, dtype=torch.bfloat16) * 0.8)(B, Sq, D)),
            "k_cache": _w((lambda *s: torch.randn(*s, dtype=torch.bfloat16) * 0.8)(B, Hkv, Sk, Dh)),
            "v_cache": _w((lambda *s: torch.randn(*s, dtype=torch.bfloat16) * 0.05)(B, Hkv, Sk, Dh)),
            "wq": _w((lambda *s: torch.randn(*s, dtype=torch.bfloat16) * 0.8)(D, Hq * Dh) * (D ** -0.5)),
            "wo": _w((lambda *s: torch.randn(*s, dtype=torch.bfloat16) * 0.05)(Hq * Dh, D) * ((Hq * Dh) ** -0.5)),
        }
    _A_in = _A_setup()

    def _B_setup():
        B, Sq, D = 32, 64, 576
        Hq, Hkv, Sk, Dh = 32, 16, 512, 128
        assert Hq % Hkv == 0, (Hq, Hkv)
        return {
            "x": _w((lambda *s: torch.randn(*s, dtype=torch.bfloat16) * 0.8)(B, Sq, D)),
            "k_cache": _w((lambda *s: torch.randn(*s, dtype=torch.bfloat16) * 0.8)(B, Hkv, Sk, Dh)),
            "v_cache": _w((lambda *s: torch.randn(*s, dtype=torch.bfloat16) * 0.05)(B, Hkv, Sk, Dh)),
            "wq": _w((lambda *s: torch.randn(*s, dtype=torch.bfloat16) * 0.8)(D, Hq * Dh) * (D ** -0.5)),
            "wo": _w((lambda *s: torch.randn(*s, dtype=torch.bfloat16) * 0.05)(Hq * Dh, D) * ((Hq * Dh) ** -0.5)),
        }
    _B_in = _B_setup()

    return {
        "A_x": _A_in["x"],
        "A_k_cache": _A_in["k_cache"],
        "A_v_cache": _A_in["v_cache"],
        "A_wq": _A_in["wq"],
        "A_wo": _A_in["wo"],
        "B_x": _B_in["x"],
        "B_k_cache": _B_in["k_cache"],
        "B_v_cache": _B_in["v_cache"],
        "B_wq": _B_in["wq"],
        "B_wo": _B_in["wo"],
    }

def reference(A_x, A_k_cache, A_v_cache, A_wq, A_wo, B_x, B_k_cache, B_v_cache, B_wq, B_wo):
    def _A_ref(x, k_cache, v_cache, wq, wo):
        B, Sq, D = x.shape
        Hq, Dh = 32, 128
        Hkv = k_cache.shape[1]
        rep = Hq // Hkv
        q = (lambda x, *d: x.permute(*d))((x @ wq).reshape(B, Sq, Hq, Dh), 0, 2, 1, 3)
        k = (lambda x, n, axis: torch.repeat_interleave(x, n, dim=axis))(k_cache, rep, axis=1)
        v = (lambda x, n, axis: torch.repeat_interleave(x, n, dim=axis))(v_cache, rep, axis=1)
        scores = torch.einsum("bhqd,bhkd->bhqk", q, k) * (Dh ** -0.5)
        p = _softmax(scores, axis=-1)
        o = torch.einsum("bhqk,bhkd->bhqd", p, v)
        return (lambda x, *d: x.permute(*d))(o, 0, 2, 1, 3).reshape(B, Sq, Hq * Dh) @ wo

    def _B_ref(x, k_cache, v_cache, wq, wo):
        B, Sq, D = x.shape
        Hq, Dh = 32, 128
        Hkv = k_cache.shape[1]
        rep = Hq // Hkv
        q = (lambda x, *d: x.permute(*d))((x @ wq).reshape(B, Sq, Hq, Dh), 0, 2, 1, 3)
        k = (lambda x, n, axis: torch.repeat_interleave(x, n, dim=axis))(k_cache, rep, axis=1)
        v = (lambda x, n, axis: torch.repeat_interleave(x, n, dim=axis))(v_cache, rep, axis=1)
        scores = torch.einsum("bhqd,bhkd->bhqk", q, k) * (Dh ** -0.5)
        p = _softmax(scores, axis=-1)
        o = torch.einsum("bhqk,bhkd->bhqd", p, v)
        return (lambda x, *d: x.permute(*d))(o, 0, 2, 1, 3).reshape(B, Sq, Hq * Dh) @ wo

    a = _A_ref(A_x, A_k_cache, A_v_cache, A_wq, A_wo)
    b = _B_ref(B_x, B_k_cache, B_v_cache, B_wq, B_wo)
    return torch.concatenate([a, b], axis=-1)
```

```asm
; @launch grid=(256,1,1) block=(512,1,1) lds=147584
.amdgcn_target "amdgcn-amd-amdhsa--gfx950"
.text

.globl concat_heads__gqa_block_cached__gqa_block_cached__near_ridge_kernel
.p2align 8
.type concat_heads__gqa_block_cached__gqa_block_cached__near_ridge_kernel,@function
concat_heads__gqa_block_cached__gqa_block_cached__near_ridge_kernel:
    s_cmp_ge_u32 s2, 0x100
    s_cbranch_scc1 Lm_done
    s_load_dwordx8 s[36:43], s[0:1], 0x0
    s_load_dwordx2 s[44:45], s[0:1], 0x20
    s_load_dwordx8 s[48:55], s[0:1], 0x28
    s_load_dwordx2 s[56:57], s[0:1], 0x48
    s_load_dwordx2 s[58:59], s[0:1], 0x60
    v_lshrrev_b32 v1, 6, v0
    s_nop 0
    v_readfirstlane_b32 s3, v1
    v_lshlrev_b32 v19, 4, v0
    v_and_b32 v0, 63, v0
    v_lshlrev_b32 v20, 4, v0
    s_bfe_u32 s4, s2, 0x10002
    s_and_b32 s5, s2, 3
    s_bfe_u32 s6, s2, 0x20003
    s_lshr_b32 s7, s2, 5
    s_lshl_b32 s26, s5, 2
    s_add_u32 s26, s26, s6
    s_and_b32 s69, s3, 3
    v_lshrrev_b32 v16, 3, v0
    s_lshl_b32 s27, s69, 6
    v_add_u32 v16, s27, v16
    v_mul_u32_u24 v16, 0x480, v16
    v_and_b32 v17, 7, v0
    v_lshrrev_b32 v18, 4, v0
    v_xor_b32 v17, v17, v18
    v_lshl_add_u32 v2, v17, 4, v16
    v_add_u32 v4, 0x4000, v2
    v_xor_b32 v17, 4, v17
    v_lshl_add_u32 v3, v17, 4, v16
    v_add_u32 v3, 0x2000, v3
    v_add_u32 v5, 0x4000, v3
    v_lshrrev_b32 v18, 5, v0
    s_lshl_b32 s27, s69, 4
    v_add_u32 v16, s27, v18
    v_lshlrev_b32 v16, 13, v16
    v_and_b32 v17, 31, v0
    v_lshlrev_b32 v18, 2, v18
    v_xor_b32 v17, v17, v18
    v_lshl_add_u32 v6, v17, 4, v16
    v_add_u32 v8, 0x7800, v6
    v_xor_b32 v17, 8, v17
    v_lshl_add_u32 v7, v17, 4, v16
    v_add_u32 v7, 0x3c00, v7
    v_add_u32 v9, 0x7800, v7
    s_mov_b32 s28, 0
    s_lshl_b32 s29, s26, 9
    s_lshl_b32 s30, s69, 13
    s_lshl_b32 s69, s69, 12
    s_waitcnt lgkmcnt(0)
    s_cmp_eq_u32 s4, 1
    s_cselect_b32 s36, s48, s36
    s_cselect_b32 s37, s49, s37
    s_cselect_b32 s38, s50, s38
    s_cselect_b32 s39, s51, s39
    s_cselect_b32 s40, s52, s40
    s_cselect_b32 s41, s53, s41
    s_cselect_b32 s42, s54, s42
    s_cselect_b32 s43, s55, s43
    s_cselect_b32 s44, s56, s44
    s_cselect_b32 s45, s57, s45
    s_mul_i32 s27, s7, 0x48000
    s_add_u32 s36, s36, s27
    s_addc_u32 s37, s37, 0
    s_mov_b32 s8, s36
    s_and_b32 s9, s37, 0xffff
    s_mov_b32 s10, 0x48000
    s_mov_b32 s11, 0x20000
    s_mov_b32 s12, s42
    s_and_b32 s13, s43, 0xffff
    s_mov_b32 s14, 0x480000
    s_mov_b32 s15, 0x20000
    s_cmp_ge_u32 s3, 4
    s_cbranch_scc1 Lgw_1
    s_add_u32 s31, s30, 0
    s_mov_b32 m0, s31
    s_add_u32 s62, s28, 0
    buffer_load_dwordx4 v2, s[8:11], s62 offen nt lds
    buffer_load_dwordx4 v3, s[8:11], s62 offen offset:1024 nt lds
    buffer_load_dwordx4 v4, s[8:11], s62 offen offset:2048 nt lds
    buffer_load_dwordx4 v5, s[8:11], s62 offen offset:3072 nt lds
    s_add_u32 s31, s30, 0x1000
    s_mov_b32 m0, s31
    s_add_u32 s62, s28, 0x9000
    buffer_load_dwordx4 v2, s[8:11], s62 offen nt lds
    buffer_load_dwordx4 v3, s[8:11], s62 offen offset:1024 nt lds
    buffer_load_dwordx4 v4, s[8:11], s62 offen offset:2048 nt lds
    buffer_load_dwordx4 v5, s[8:11], s62 offen offset:3072 nt lds
    s_branch Lgd_2
Lgw_1:
    s_add_u32 s31, s30, 0x8000
    s_mov_b32 m0, s31
    s_add_u32 s62, s29, 0
    buffer_load_dwordx4 v6, s[12:15], s62 offen nt lds
    buffer_load_dwordx4 v7, s[12:15], s62 offen offset:1024 nt lds
    buffer_load_dwordx4 v8, s[12:15], s62 offen offset:2048 nt lds
    buffer_load_dwordx4 v9, s[12:15], s62 offen offset:3072 nt lds
    s_add_u32 s31, s30, 0x9000
    s_mov_b32 m0, s31
    s_add_u32 s62, s29, 0x10000
    buffer_load_dwordx4 v6, s[12:15], s62 offen nt lds
    buffer_load_dwordx4 v7, s[12:15], s62 offen offset:1024 nt lds
    buffer_load_dwordx4 v8, s[12:15], s62 offen offset:2048 nt lds
    buffer_load_dwordx4 v9, s[12:15], s62 offen offset:3072 nt lds
Lgd_2:
    s_add_u32 s28, s28, 0x80
    s_add_u32 s29, s29, 0x80000
    s_xor_b32 s30, s30, 0x10000
    s_lshl_b32 s32, s5, 5
    s_lshr_b32 s33, s2, 3
    s_add_u32 s32, s32, s33
    s_mul_i32 s33, s32, 0x9000
    s_add_u32 s44, s44, s33
    s_addc_u32 s45, s45, 0
    s_mov_b32 s16, s44
    s_and_b32 s17, s45, 0xffff
    s_mov_b32 s18, 0x9000
    s_mov_b32 s19, 0x20000
    s_mov_b32 s33, 0
    buffer_load_dwordx4 v[24:27], v19, s[16:19], s33 offen nt
    s_add_u32 s33, s33, 0x2000
    buffer_load_dwordx4 v[28:31], v19, s[16:19], s33 offen nt
    s_add_u32 s33, s33, 0x2000
    buffer_load_dwordx4 v[32:35], v19, s[16:19], s33 offen nt
    s_add_u32 s33, s33, 0x2000
    buffer_load_dwordx4 v[36:39], v19, s[16:19], s33 offen nt
    s_add_u32 s33, s33, 0x2000
    buffer_load_dwordx4 v[40:43], v19, s[16:19], s33 offen nt
    s_lshr_b32 s33, s2, 3
    s_lshl_b32 s33, s33, 4
    s_add_u32 s33, s33, s26
    s_lshl_b32 s33, s33, 17
    s_add_u32 s38, s38, s33
    s_addc_u32 s39, s39, 0
    s_add_u32 s40, s40, s33
    s_addc_u32 s41, s41, 0
    s_mov_b32 s72, s38
    s_and_b32 s73, s39, 0xffff
    s_mov_b32 s74, 0x20000
    s_mov_b32 s75, 0x20000
    s_mov_b32 s76, s40
    s_and_b32 s77, s41, 0xffff
    s_mov_b32 s78, 0x20000
    s_mov_b32 s79, 0x20000
    v_lshrrev_b32 v18, 4, v0
    v_and_b32 v16, 15, v0
    v_lshl_add_u32 v17, v18, 8, s69
    v_add_u32 v96, 0, v18
    v_xor_b32 v96, v96, v16
    v_lshl_add_u32 v96, v96, 4, v17
    v_add_u32 v97, 4, v18
    v_xor_b32 v97, v97, v16
    v_lshl_add_u32 v97, v97, 4, v17
    v_add_u32 v98, 8, v18
    v_xor_b32 v98, v98, v16
    v_lshl_add_u32 v98, v98, 4, v17
    v_add_u32 v99, 12, v18
    v_xor_b32 v99, v99, v16
    v_lshl_add_u32 v99, v99, 4, v17
    v_lshlrev_b32 v100, 2, v18
    v_xor_b32 v100, v100, v16
    v_lshl_add_u32 v100, v100, 4, v17
    s_and_b32 s27, s3, 1
    s_lshr_b32 s35, s3, 1
    v_and_b32 v16, 31, v0
    v_bfe_u32 v17, v0, 1, 3
    v_lshrrev_b32 v18, 5, v0
    v_xor_b32 v17, v17, v18
    v_lshlrev_b32 v16, 7, v16
    v_lshl_add_u32 v16, v17, 4, v16
    s_lshl_b32 s33, s27, 14
    v_add_u32 v10, s33, v16
    v_xor_b32 v11, 32, v10
    v_xor_b32 v12, 64, v10
    v_xor_b32 v13, 0x60, v10
    v_bfe_u32 v23, v0, 4, 1
    v_lshlrev_b32 v23, 5, v23
    v_and_b32 v16, 1, v0
    v_lshl_add_u32 v23, v16, 4, v23
    v_bfe_u32 v16, v0, 1, 1
    v_lshl_add_u32 v23, v16, 3, v23
    v_bfe_u32 v17, v0, 2, 2
    s_lshl_b32 s33, s35, 7
    v_add_u32 v16, s33, v23
    v_lshlrev_b32 v14, 6, v17
    v_xor_b32 v16, v16, v14
    v_lshl_add_u32 v14, v18, 3, v17
    v_lshl_add_u32 v14, v14, 9, v16
    v_add_u32 v14, 0x8000, v14
    v_xor_b32 v15, 64, v14
    v_mov_b32 v128, 0
    v_mov_b32 v129, 0
    v_mov_b32 v130, 0
    v_mov_b32 v131, 0
    v_mov_b32 v132, 0
    v_mov_b32 v133, 0
    v_mov_b32 v134, 0
    v_mov_b32 v135, 0
    v_mov_b32 v136, 0
    v_mov_b32 v137, 0
    v_mov_b32 v138, 0
    v_mov_b32 v139, 0
    v_mov_b32 v140, 0
    v_mov_b32 v141, 0
    v_mov_b32 v142, 0
    v_mov_b32 v143, 0
    v_mov_b32 v144, 0
    v_mov_b32 v145, 0
    v_mov_b32 v146, 0
    v_mov_b32 v147, 0
    v_mov_b32 v148, 0
    v_mov_b32 v149, 0
    v_mov_b32 v150, 0
    v_mov_b32 v151, 0
    v_mov_b32 v152, 0
    v_mov_b32 v153, 0
    v_mov_b32 v154, 0
    v_mov_b32 v155, 0
    v_mov_b32 v156, 0
    v_mov_b32 v157, 0
    v_mov_b32 v158, 0
    v_mov_b32 v159, 0
    v_mov_b32 v160, 0
    v_mov_b32 v161, 0
    v_mov_b32 v162, 0
    v_mov_b32 v163, 0
    v_mov_b32 v164, 0
    v_mov_b32 v165, 0
    v_mov_b32 v166, 0
    v_mov_b32 v167, 0
    v_mov_b32 v168, 0
    v_mov_b32 v169, 0
    v_mov_b32 v170, 0
    v_mov_b32 v171, 0
    v_mov_b32 v172, 0
    v_mov_b32 v173, 0
    v_mov_b32 v174, 0
    v_mov_b32 v175, 0
    v_mov_b32 v176, 0
    v_mov_b32 v177, 0
    v_mov_b32 v178, 0
    v_mov_b32 v179, 0
    v_mov_b32 v180, 0
    v_mov_b32 v181, 0
    v_mov_b32 v182, 0
    v_mov_b32 v183, 0
    v_mov_b32 v184, 0
    v_mov_b32 v185, 0
    v_mov_b32 v186, 0
    v_mov_b32 v187, 0
    v_mov_b32 v188, 0
    v_mov_b32 v189, 0
    v_mov_b32 v190, 0
    v_mov_b32 v191, 0
    v_mov_b32 v192, 0
    v_mov_b32 v193, 0
    v_mov_b32 v194, 0
    v_mov_b32 v195, 0
    v_mov_b32 v196, 0
    v_mov_b32 v197, 0
    v_mov_b32 v198, 0
    v_mov_b32 v199, 0
    v_mov_b32 v200, 0
    v_mov_b32 v201, 0
    v_mov_b32 v202, 0
    v_mov_b32 v203, 0
    v_mov_b32 v204, 0
    v_mov_b32 v205, 0
    v_mov_b32 v206, 0
    v_mov_b32 v207, 0
    v_mov_b32 v208, 0
    v_mov_b32 v209, 0
    v_mov_b32 v210, 0
    v_mov_b32 v211, 0
    v_mov_b32 v212, 0
    v_mov_b32 v213, 0
    v_mov_b32 v214, 0
    v_mov_b32 v215, 0
    v_mov_b32 v216, 0
    v_mov_b32 v217, 0
    v_mov_b32 v218, 0
    v_mov_b32 v219, 0
    v_mov_b32 v220, 0
    v_mov_b32 v221, 0
    v_mov_b32 v222, 0
    v_mov_b32 v223, 0
    v_mov_b32 v224, 0
    v_mov_b32 v225, 0
    v_mov_b32 v226, 0
    v_mov_b32 v227, 0
    v_mov_b32 v228, 0
    v_mov_b32 v229, 0
    v_mov_b32 v230, 0
    v_mov_b32 v231, 0
    v_mov_b32 v232, 0
    v_mov_b32 v233, 0
    v_mov_b32 v234, 0
    v_mov_b32 v235, 0
    v_mov_b32 v236, 0
    v_mov_b32 v237, 0
    v_mov_b32 v238, 0
    v_mov_b32 v239, 0
    v_mov_b32 v240, 0
    v_mov_b32 v241, 0
    v_mov_b32 v242, 0
    v_mov_b32 v243, 0
    v_mov_b32 v244, 0
    v_mov_b32 v245, 0
    v_mov_b32 v246, 0
    v_mov_b32 v247, 0
    v_mov_b32 v248, 0
    v_mov_b32 v249, 0
    v_mov_b32 v250, 0
    v_mov_b32 v251, 0
    v_mov_b32 v252, 0
    v_mov_b32 v253, 0
    v_mov_b32 v254, 0
    v_mov_b32 v255, 0
    s_mov_b32 s33, 0
    s_waitcnt vmcnt(5)
Lg_loop:
    s_barrier
    ds_read_b64_tr_b16 v[48:49], v14
    ds_read_b64_tr_b16 v[50:51], v14 offset:2048
    ds_read_b64_tr_b16 v[52:53], v15
    ds_read_b64_tr_b16 v[54:55], v15 offset:2048
    ds_read_b128 v[64:67], v10
    ds_read_b128 v[68:71], v10 offset:4096
    ds_read_b128 v[72:75], v10 offset:8192
    ds_read_b128 v[76:79], v10 offset:12288
    s_cmp_eq_u32 s33, 8
    s_cbranch_scc1 Lg_kv
    s_cmp_ge_u32 s3, 4
    s_cbranch_scc1 Lgw_3
    s_add_u32 s31, s30, 0
    s_mov_b32 m0, s31
    s_add_u32 s62, s28, 0
    buffer_load_dwordx4 v2, s[8:11], s62 offen nt lds
    buffer_load_dwordx4 v3, s[8:11], s62 offen offset:1024 nt lds
    buffer_load_dwordx4 v4, s[8:11], s62 offen offset:2048 nt lds
    buffer_load_dwordx4 v5, s[8:11], s62 offen offset:3072 nt lds
    s_add_u32 s31, s30, 0x1000
    s_mov_b32 m0, s31
    s_add_u32 s62, s28, 0x9000
    buffer_load_dwordx4 v2, s[8:11], s62 offen nt lds
    buffer_load_dwordx4 v3, s[8:11], s62 offen offset:1024 nt lds
    buffer_load_dwordx4 v4, s[8:11], s62 offen offset:2048 nt lds
    buffer_load_dwordx4 v5, s[8:11], s62 offen offset:3072 nt lds
    s_branch Lgd_4
Lgw_3:
    s_add_u32 s31, s30, 0x8000
    s_mov_b32 m0, s31
    s_add_u32 s62, s29, 0
    buffer_load_dwordx4 v6, s[12:15], s62 offen nt lds
    buffer_load_dwordx4 v7, s[12:15], s62 offen offset:1024 nt lds
    buffer_load_dwordx4 v8, s[12:15], s62 offen offset:2048 nt lds
    buffer_load_dwordx4 v9, s[12:15], s62 offen offset:3072 nt lds
    s_add_u32 s31, s30, 0x9000
    s_mov_b32 m0, s31
    s_add_u32 s62, s29, 0x10000
    buffer_load_dwordx4 v6, s[12:15], s62 offen nt lds
    buffer_load_dwordx4 v7, s[12:15], s62 offen offset:1024 nt lds
    buffer_load_dwordx4 v8, s[12:15], s62 offen offset:2048 nt lds
    buffer_load_dwordx4 v9, s[12:15], s62 offen offset:3072 nt lds
Lgd_4:
    s_add_u32 s28, s28, 0x80
    s_add_u32 s29, s29, 0x80000
    s_xor_b32 s30, s30, 0x10000
    s_branch Lg_go
Lg_kv:
    s_cmp_lt_u32 s3, 4
    s_cbranch_scc1 Lg_go
    s_movk_i32 s70, 0x4000
    s_add_u32 s62, s69, 0x10000
    s_mov_b32 m0, s62
    s_nop 0
    buffer_load_dwordx4 v96, s[72:75], 0 offen nt lds
    buffer_load_dwordx4 v97, s[72:75], 0 offen offset:1024 nt lds
    buffer_load_dwordx4 v98, s[72:75], 0 offen offset:2048 nt lds
    buffer_load_dwordx4 v99, s[72:75], 0 offen offset:3072 nt lds
    s_add_u32 s62, s69, 0x14000
    s_mov_b32 m0, s62
    s_nop 0
    buffer_load_dwordx4 v96, s[72:75], s70 offen nt lds
    buffer_load_dwordx4 v97, s[72:75], s70 offen offset:1024 nt lds
    buffer_load_dwordx4 v98, s[72:75], s70 offen offset:2048 nt lds
    buffer_load_dwordx4 v99, s[72:75], s70 offen offset:3072 nt lds
    s_add_u32 s62, s69, 0x18000
    s_mov_b32 m0, s62
    s_nop 0
    buffer_load_dwordx4 v100, s[76:79], 0 offen nt lds
    buffer_load_dwordx4 v100, s[76:79], 0 offen offset:1024 nt lds
    buffer_load_dwordx4 v100, s[76:79], 0 offen offset:2048 nt lds
    buffer_load_dwordx4 v100, s[76:79], 0 offen offset:3072 nt lds
Lg_go:
    ds_read_b64_tr_b16 v[56:57], v14 offset:8192
    ds_read_b64_tr_b16 v[58:59], v14 offset:10240
    ds_read_b64_tr_b16 v[60:61], v15 offset:8192
    ds_read_b64_tr_b16 v[62:63], v15 offset:10240
    ds_read_b128 v[80:83], v11
    ds_read_b128 v[84:87], v11 offset:4096
    ds_read_b128 v[88:91], v11 offset:8192
    ds_read_b128 v[92:95], v11 offset:12288
    s_waitcnt lgkmcnt(8)
    v_mfma_f32_32x32x16_bf16 v[128:143], v[48:51], v[64:67], v[128:143]
    v_mfma_f32_32x32x16_bf16 v[144:159], v[48:51], v[68:71], v[144:159]
    v_mfma_f32_32x32x16_bf16 v[160:175], v[48:51], v[72:75], v[160:175]
    v_mfma_f32_32x32x16_bf16 v[176:191], v[48:51], v[76:79], v[176:191]
    v_mfma_f32_32x32x16_bf16 v[192:207], v[52:55], v[64:67], v[192:207]
    v_mfma_f32_32x32x16_bf16 v[208:223], v[52:55], v[68:71], v[208:223]
    v_mfma_f32_32x32x16_bf16 v[224:239], v[52:55], v[72:75], v[224:239]
    v_mfma_f32_32x32x16_bf16 v[240:255], v[52:55], v[76:79], v[240:255]
    ds_read_b64_tr_b16 v[48:49], v14 offset:16384
    ds_read_b64_tr_b16 v[50:51], v14 offset:18432
    ds_read_b64_tr_b16 v[52:53], v15 offset:16384
    ds_read_b64_tr_b16 v[54:55], v15 offset:18432
    ds_read_b128 v[64:67], v12
    ds_read_b128 v[68:71], v12 offset:4096
    ds_read_b128 v[72:75], v12 offset:8192
    ds_read_b128 v[76:79], v12 offset:12288
    s_waitcnt lgkmcnt(8)
    v_mfma_f32_32x32x16_bf16 v[128:143], v[56:59], v[80:83], v[128:143]
    v_mfma_f32_32x32x16_bf16 v[144:159], v[56:59], v[84:87], v[144:159]
    v_mfma_f32_32x32x16_bf16 v[160:175], v[56:59], v[88:91], v[160:175]
    v_mfma_f32_32x32x16_bf16 v[176:191], v[56:59], v[92:95], v[176:191]
    v_mfma_f32_32x32x16_bf16 v[192:207], v[60:63], v[80:83], v[192:207]
    v_mfma_f32_32x32x16_bf16 v[208:223], v[60:63], v[84:87], v[208:223]
    v_mfma_f32_32x32x16_bf16 v[224:239], v[60:63], v[88:91], v[224:239]
    v_mfma_f32_32x32x16_bf16 v[240:255], v[60:63], v[92:95], v[240:255]
    ds_read_b64_tr_b16 v[56:57], v14 offset:24576
    ds_read_b64_tr_b16 v[58:59], v14 offset:26624
    ds_read_b64_tr_b16 v[60:61], v15 offset:24576
    ds_read_b64_tr_b16 v[62:63], v15 offset:26624
    ds_read_b128 v[80:83], v13
    ds_read_b128 v[84:87], v13 offset:4096
    ds_read_b128 v[88:91], v13 offset:8192
    ds_read_b128 v[92:95], v13 offset:12288
    s_waitcnt lgkmcnt(8)
    v_mfma_f32_32x32x16_bf16 v[128:143], v[48:51], v[64:67], v[128:143]
    v_mfma_f32_32x32x16_bf16 v[144:159], v[48:51], v[68:71], v[144:159]
    v_mfma_f32_32x32x16_bf16 v[160:175], v[48:51], v[72:75], v[160:175]
    v_mfma_f32_32x32x16_bf16 v[176:191], v[48:51], v[76:79], v[176:191]
    v_mfma_f32_32x32x16_bf16 v[192:207], v[52:55], v[64:67], v[192:207]
    v_mfma_f32_32x32x16_bf16 v[208:223], v[52:55], v[68:71], v[208:223]
    v_mfma_f32_32x32x16_bf16 v[224:239], v[52:55], v[72:75], v[224:239]
    v_mfma_f32_32x32x16_bf16 v[240:255], v[52:55], v[76:79], v[240:255]
    s_waitcnt lgkmcnt(0)
    v_mfma_f32_32x32x16_bf16 v[128:143], v[56:59], v[80:83], v[128:143]
    v_mfma_f32_32x32x16_bf16 v[144:159], v[56:59], v[84:87], v[144:159]
    v_mfma_f32_32x32x16_bf16 v[160:175], v[56:59], v[88:91], v[160:175]
    v_mfma_f32_32x32x16_bf16 v[176:191], v[56:59], v[92:95], v[176:191]
    v_mfma_f32_32x32x16_bf16 v[192:207], v[60:63], v[80:83], v[192:207]
    v_mfma_f32_32x32x16_bf16 v[208:223], v[60:63], v[84:87], v[208:223]
    v_mfma_f32_32x32x16_bf16 v[224:239], v[60:63], v[88:91], v[224:239]
    v_mfma_f32_32x32x16_bf16 v[240:255], v[60:63], v[92:95], v[240:255]
    v_xor_b32 v10, 0x10000, v10
    v_xor_b32 v11, 0x10000, v11
    v_xor_b32 v12, 0x10000, v12
    v_xor_b32 v13, 0x10000, v13
    v_xor_b32 v14, 0x10000, v14
    v_xor_b32 v15, 0x10000, v15
    s_add_u32 s33, s33, 1
    s_cmp_eq_u32 s33, 9
    s_nop 3
    s_cbranch_scc1 Lg_last
    s_waitcnt vmcnt(0)
    s_branch Lg_loop
Lg_last:
    s_barrier
    ds_write_b128 v19, v[24:27]
    ds_write_b128 v19, v[28:31] offset:8192
    ds_write_b128 v19, v[32:35] offset:16384
    ds_write_b128 v19, v[36:39] offset:24576
    ds_write_b128 v19, v[40:43] offset:32768
    s_add_u32 s60, s58, 0x3c00000
    s_addc_u32 s61, s59, 0
    s_mov_b32 s16, s60
    s_and_b32 s17, s61, 0xffff
    s_mov_b32 s18, 0x2000
    s_mov_b32 s19, 0x20000
    s_lshl_b32 s28, s4, 5
    s_lshr_b32 s29, s2, 3
    s_add_u32 s28, s28, s29
    s_lshl_b32 s28, s28, 7
    s_or_b32 s29, s3, s5
    s_cmp_lg_u32 s29, 0
    s_cselect_b32 s28, 0x10000000, s28
    v_and_b32 v16, 31, v0
    v_lshlrev_b32 v16, 2, v16
    v_mov_b32 v17, 0
    buffer_store_dword v17, v16, s[16:19], s28 offen sc1
    s_mov_b32 s12, s58
    s_and_b32 s13, s59, 0xffff
    s_mov_b32 s14, 0xa00000
    s_mov_b32 s15, 0x20000
    v_lshrrev_b32 v18, 5, v0
    v_bfe_u32 v17, v0, 2, 2
    v_lshl_add_u32 v16, v18, 2, v17
    v_mul_u32_u24 v16, 0x480, v16
    v_add_u32 v16, v16, v23
    s_mul_i32 s28, s27, 0x4800
    s_add_u32 s29, s35, 1
    s_lshr_b32 s29, s29, 1
    s_lshl_b32 s30, s35, 2
    s_add_u32 s29, s29, s30
    s_lshl_b32 s29, s29, 6
    s_add_u32 s29, s29, s28
    v_add_u32 v17, s29, v16
    s_lshr_b32 s29, s35, 1
    s_mul_i32 s29, s29, 0x240
    s_add_u32 s29, s29, 0x100
    s_add_u32 s29, s29, s28
    v_add_u32 v18, s29, v16
    s_lshl_b32 s28, s4, 2
    s_add_u32 s28, s28, s35
    s_lshl_b32 s28, s28, 7
    s_add_u32 s28, s28, s32
    s_mul_i32 s28, s28, 0x2800
    s_mul_i32 s29, s27, 0x1400
    s_add_u32 s28, s28, s29
    s_add_u32 s29, s28, 0x1000
    s_waitcnt lgkmcnt(0)
    s_barrier
    ds_read_b64_tr_b16 v[48:49], v17
    ds_read_b64_tr_b16 v[50:51], v17 offset:9216
    ds_read_b64_tr_b16 v[52:53], v17 offset:64
    ds_read_b64_tr_b16 v[54:55], v17 offset:9280
    ds_read_b64_tr_b16 v[56:57], v17 offset:128
    ds_read_b64_tr_b16 v[58:59], v17 offset:9344
    ds_read_b64_tr_b16 v[60:61], v17 offset:192
    ds_read_b64_tr_b16 v[62:63], v17 offset:9408
    ds_read_b64_tr_b16 v[64:65], v18
    ds_read_b64_tr_b16 v[66:67], v18 offset:9216
    s_waitcnt lgkmcnt(8)
    buffer_store_dwordx4 v[48:51], v20, s[12:15], s28 offen sc1
    s_waitcnt lgkmcnt(6)
    buffer_store_dwordx4 v[52:55], v20, s[12:15], s28 offen offset:1024 sc1
    s_waitcnt lgkmcnt(4)
    buffer_store_dwordx4 v[56:59], v20, s[12:15], s28 offen offset:2048 sc1
    s_waitcnt lgkmcnt(2)
    buffer_store_dwordx4 v[60:63], v20, s[12:15], s28 offen offset:3072 sc1
    s_waitcnt lgkmcnt(0)
    buffer_store_dwordx4 v[64:67], v20, s[12:15], s29 offen sc1
    s_lshl_b32 s28, s4, 5
    s_lshl_b32 s29, s7, 2
    s_add_u32 s28, s28, s29
    s_lshl_b32 s29, s27, 1
    s_add_u32 s28, s28, s29
    s_lshl_b32 s28, s28, 2
    s_add_u32 s28, s28, s5
    s_lshl_b32 s28, s28, 17
    s_lshl_b32 s29, s6, 15
    s_add_u32 s28, s28, s29
    s_lshr_b32 s29, s35, 1
    s_lshl_b32 s29, s29, 14
    s_add_u32 s28, s28, s29
    s_and_b32 s29, s35, 1
    s_lshl_b32 s29, s29, 12
    s_add_u32 s28, s28, s29
    s_add_u32 s60, s58, 0xa00000
    s_addc_u32 s61, s59, 0
    s_mov_b32 s8, s60
    s_and_b32 s9, s61, 0xffff
    s_mov_b32 s10, 0x2000000
    s_mov_b32 s11, 0x20000
    s_mov_b32 s31, 0x3e0293ee
    s_add_u32 s29, s28, 0
    s_lshl_b32 s30, s27, 1
    s_add_u32 s30, s30, 0
    s_cmp_eq_u32 s30, s6
    s_cselect_b32 s29, 0x10000000, s29
    v_mul_f32 v128, s31, v128
    v_mul_f32 v129, s31, v129
    v_mul_f32 v130, s31, v130
    v_mul_f32 v131, s31, v131
    v_mul_f32 v132, s31, v132
    v_mul_f32 v133, s31, v133
    v_mul_f32 v134, s31, v134
    v_mul_f32 v135, s31, v135
    v_cvt_pk_bf16_f32 v128, v128, v129
    v_cvt_pk_bf16_f32 v129, v130, v131
    v_cvt_pk_bf16_f32 v130, v132, v133
    v_cvt_pk_bf16_f32 v131, v134, v135
    buffer_store_dwordx4 v[128:131], v20, s[8:11], s29 offen sc1
    v_mul_f32 v136, s31, v136
    v_mul_f32 v137, s31, v137
    v_mul_f32 v138, s31, v138
    v_mul_f32 v139, s31, v139
    v_mul_f32 v140, s31, v140
    v_mul_f32 v141, s31, v141
    v_mul_f32 v142, s31, v142
    v_mul_f32 v143, s31, v143
    v_cvt_pk_bf16_f32 v136, v136, v137
    v_cvt_pk_bf16_f32 v137, v138, v139
    v_cvt_pk_bf16_f32 v138, v140, v141
    v_cvt_pk_bf16_f32 v139, v142, v143
    buffer_store_dwordx4 v[136:139], v20, s[8:11], s29 offen offset:1024 sc1
    v_mul_f32 v192, s31, v192
    v_mul_f32 v193, s31, v193
    v_mul_f32 v194, s31, v194
    v_mul_f32 v195, s31, v195
    v_mul_f32 v196, s31, v196
    v_mul_f32 v197, s31, v197
    v_mul_f32 v198, s31, v198
    v_mul_f32 v199, s31, v199
    v_cvt_pk_bf16_f32 v192, v192, v193
    v_cvt_pk_bf16_f32 v193, v194, v195
    v_cvt_pk_bf16_f32 v194, v196, v197
    v_cvt_pk_bf16_f32 v195, v198, v199
    buffer_store_dwordx4 v[192:195], v20, s[8:11], s29 offen offset:2048 sc1
    v_mul_f32 v200, s31, v200
    v_mul_f32 v201, s31, v201
    v_mul_f32 v202, s31, v202
    v_mul_f32 v203, s31, v203
    v_mul_f32 v204, s31, v204
    v_mul_f32 v205, s31, v205
    v_mul_f32 v206, s31, v206
    v_mul_f32 v207, s31, v207
    v_cvt_pk_bf16_f32 v200, v200, v201
    v_cvt_pk_bf16_f32 v201, v202, v203
    v_cvt_pk_bf16_f32 v202, v204, v205
    v_cvt_pk_bf16_f32 v203, v206, v207
    buffer_store_dwordx4 v[200:203], v20, s[8:11], s29 offen offset:3072 sc1
    s_add_u32 s29, s28, 0x2000
    s_lshl_b32 s30, s27, 1
    s_add_u32 s30, s30, 0
    s_cmp_eq_u32 s30, s6
    s_cselect_b32 s29, 0x10000000, s29
    v_mul_f32 v144, s31, v144
    v_mul_f32 v145, s31, v145
    v_mul_f32 v146, s31, v146
    v_mul_f32 v147, s31, v147
    v_mul_f32 v148, s31, v148
    v_mul_f32 v149, s31, v149
    v_mul_f32 v150, s31, v150
    v_mul_f32 v151, s31, v151
    v_cvt_pk_bf16_f32 v144, v144, v145
    v_cvt_pk_bf16_f32 v145, v146, v147
    v_cvt_pk_bf16_f32 v146, v148, v149
    v_cvt_pk_bf16_f32 v147, v150, v151
    buffer_store_dwordx4 v[144:147], v20, s[8:11], s29 offen sc1
    v_mul_f32 v152, s31, v152
    v_mul_f32 v153, s31, v153
    v_mul_f32 v154, s31, v154
    v_mul_f32 v155, s31, v155
    v_mul_f32 v156, s31, v156
    v_mul_f32 v157, s31, v157
    v_mul_f32 v158, s31, v158
    v_mul_f32 v159, s31, v159
    v_cvt_pk_bf16_f32 v152, v152, v153
    v_cvt_pk_bf16_f32 v153, v154, v155
    v_cvt_pk_bf16_f32 v154, v156, v157
    v_cvt_pk_bf16_f32 v155, v158, v159
    buffer_store_dwordx4 v[152:155], v20, s[8:11], s29 offen offset:1024 sc1
    v_mul_f32 v208, s31, v208
    v_mul_f32 v209, s31, v209
    v_mul_f32 v210, s31, v210
    v_mul_f32 v211, s31, v211
    v_mul_f32 v212, s31, v212
    v_mul_f32 v213, s31, v213
    v_mul_f32 v214, s31, v214
    v_mul_f32 v215, s31, v215
    v_cvt_pk_bf16_f32 v208, v208, v209
    v_cvt_pk_bf16_f32 v209, v210, v211
    v_cvt_pk_bf16_f32 v210, v212, v213
    v_cvt_pk_bf16_f32 v211, v214, v215
    buffer_store_dwordx4 v[208:211], v20, s[8:11], s29 offen offset:2048 sc1
    v_mul_f32 v216, s31, v216
    v_mul_f32 v217, s31, v217
    v_mul_f32 v218, s31, v218
    v_mul_f32 v219, s31, v219
    v_mul_f32 v220, s31, v220
    v_mul_f32 v221, s31, v221
    v_mul_f32 v222, s31, v222
    v_mul_f32 v223, s31, v223
    v_cvt_pk_bf16_f32 v216, v216, v217
    v_cvt_pk_bf16_f32 v217, v218, v219
    v_cvt_pk_bf16_f32 v218, v220, v221
    v_cvt_pk_bf16_f32 v219, v222, v223
    buffer_store_dwordx4 v[216:219], v20, s[8:11], s29 offen offset:3072 sc1
    s_add_u32 s29, s28, 0x80000
    s_lshl_b32 s30, s27, 1
    s_add_u32 s30, s30, 1
    s_cmp_eq_u32 s30, s6
    s_cselect_b32 s29, 0x10000000, s29
    v_mul_f32 v160, s31, v160
    v_mul_f32 v161, s31, v161
    v_mul_f32 v162, s31, v162
    v_mul_f32 v163, s31, v163
    v_mul_f32 v164, s31, v164
    v_mul_f32 v165, s31, v165
    v_mul_f32 v166, s31, v166
    v_mul_f32 v167, s31, v167
    v_cvt_pk_bf16_f32 v160, v160, v161
    v_cvt_pk_bf16_f32 v161, v162, v163
    v_cvt_pk_bf16_f32 v162, v164, v165
    v_cvt_pk_bf16_f32 v163, v166, v167
    buffer_store_dwordx4 v[160:163], v20, s[8:11], s29 offen sc1
    v_mul_f32 v168, s31, v168
    v_mul_f32 v169, s31, v169
    v_mul_f32 v170, s31, v170
    v_mul_f32 v171, s31, v171
    v_mul_f32 v172, s31, v172
    v_mul_f32 v173, s31, v173
    v_mul_f32 v174, s31, v174
    v_mul_f32 v175, s31, v175
    v_cvt_pk_bf16_f32 v168, v168, v169
    v_cvt_pk_bf16_f32 v169, v170, v171
    v_cvt_pk_bf16_f32 v170, v172, v173
    v_cvt_pk_bf16_f32 v171, v174, v175
    buffer_store_dwordx4 v[168:171], v20, s[8:11], s29 offen offset:1024 sc1
    v_mul_f32 v224, s31, v224
    v_mul_f32 v225, s31, v225
    v_mul_f32 v226, s31, v226
    v_mul_f32 v227, s31, v227
    v_mul_f32 v228, s31, v228
    v_mul_f32 v229, s31, v229
    v_mul_f32 v230, s31, v230
    v_mul_f32 v231, s31, v231
    v_cvt_pk_bf16_f32 v224, v224, v225
    v_cvt_pk_bf16_f32 v225, v226, v227
    v_cvt_pk_bf16_f32 v226, v228, v229
    v_cvt_pk_bf16_f32 v227, v230, v231
    buffer_store_dwordx4 v[224:227], v20, s[8:11], s29 offen offset:2048 sc1
    v_mul_f32 v232, s31, v232
    v_mul_f32 v233, s31, v233
    v_mul_f32 v234, s31, v234
    v_mul_f32 v235, s31, v235
    v_mul_f32 v236, s31, v236
    v_mul_f32 v237, s31, v237
    v_mul_f32 v238, s31, v238
    v_mul_f32 v239, s31, v239
    v_cvt_pk_bf16_f32 v232, v232, v233
    v_cvt_pk_bf16_f32 v233, v234, v235
    v_cvt_pk_bf16_f32 v234, v236, v237
    v_cvt_pk_bf16_f32 v235, v238, v239
    buffer_store_dwordx4 v[232:235], v20, s[8:11], s29 offen offset:3072 sc1
    s_add_u32 s29, s28, 0x82000
    s_lshl_b32 s30, s27, 1
    s_add_u32 s30, s30, 1
    s_cmp_eq_u32 s30, s6
    s_cselect_b32 s29, 0x10000000, s29
    v_mul_f32 v176, s31, v176
    v_mul_f32 v177, s31, v177
    v_mul_f32 v178, s31, v178
    v_mul_f32 v179, s31, v179
    v_mul_f32 v180, s31, v180
    v_mul_f32 v181, s31, v181
    v_mul_f32 v182, s31, v182
    v_mul_f32 v183, s31, v183
    v_cvt_pk_bf16_f32 v176, v176, v177
    v_cvt_pk_bf16_f32 v177, v178, v179
    v_cvt_pk_bf16_f32 v178, v180, v181
    v_cvt_pk_bf16_f32 v179, v182, v183
    buffer_store_dwordx4 v[176:179], v20, s[8:11], s29 offen sc1
    v_mul_f32 v184, s31, v184
    v_mul_f32 v185, s31, v185
    v_mul_f32 v186, s31, v186
    v_mul_f32 v187, s31, v187
    v_mul_f32 v188, s31, v188
    v_mul_f32 v189, s31, v189
    v_mul_f32 v190, s31, v190
    v_mul_f32 v191, s31, v191
    v_cvt_pk_bf16_f32 v184, v184, v185
    v_cvt_pk_bf16_f32 v185, v186, v187
    v_cvt_pk_bf16_f32 v186, v188, v189
    v_cvt_pk_bf16_f32 v187, v190, v191
    buffer_store_dwordx4 v[184:187], v20, s[8:11], s29 offen offset:1024 sc1
    v_mul_f32 v240, s31, v240
    v_mul_f32 v241, s31, v241
    v_mul_f32 v242, s31, v242
    v_mul_f32 v243, s31, v243
    v_mul_f32 v244, s31, v244
    v_mul_f32 v245, s31, v245
    v_mul_f32 v246, s31, v246
    v_mul_f32 v247, s31, v247
    v_cvt_pk_bf16_f32 v240, v240, v241
    v_cvt_pk_bf16_f32 v241, v242, v243
    v_cvt_pk_bf16_f32 v242, v244, v245
    v_cvt_pk_bf16_f32 v243, v246, v247
    buffer_store_dwordx4 v[240:243], v20, s[8:11], s29 offen offset:2048 sc1
    v_mul_f32 v248, s31, v248
    v_mul_f32 v249, s31, v249
    v_mul_f32 v250, s31, v250
    v_mul_f32 v251, s31, v251
    v_mul_f32 v252, s31, v252
    v_mul_f32 v253, s31, v253
    v_mul_f32 v254, s31, v254
    v_mul_f32 v255, s31, v255
    v_cvt_pk_bf16_f32 v248, v248, v249
    v_cvt_pk_bf16_f32 v249, v250, v251
    v_cvt_pk_bf16_f32 v250, v252, v253
    v_cvt_pk_bf16_f32 v251, v254, v255
    buffer_store_dwordx4 v[248:251], v20, s[8:11], s29 offen offset:3072 sc1
    s_load_dwordx4 s[36:39], s[0:1], 0x0
    s_load_dwordx2 s[40:41], s[0:1], 0x10
    s_load_dwordx4 s[44:47], s[0:1], 0x28
    s_load_dwordx2 s[48:49], s[0:1], 0x38
    s_load_dwordx4 s[52:55], s[0:1], 0x50
    s_load_dwordx2 s[56:57], s[0:1], 0x60
    v_and_b32 v1, 31, v0
    v_lshlrev_b32 v1, 2, v1
    v_add_u32 v1, 0x24000, v1
    v_mov_b32 v2, 0
    ds_write_b32 v1, v2
    s_bfe_u32 s4, s2, 0x10002
    s_and_b32 s5, s2, 3
    s_lshr_b32 s6, s2, 3
    s_lshl_b32 s7, s4, 5
    s_add_u32 s7, s7, s6
    s_waitcnt lgkmcnt(0)
    s_barrier
    s_bfe_u32 s58, s6, 0x10001
    s_and_b32 s59, s3, 1
    s_cmp_lg_u32 s58, s59
    s_cbranch_scc1 Lm_noq
    s_lshr_b32 s59, s3, 2
    s_lshl_b32 s59, s59, 14
    s_bfe_u32 s58, s3, 0x10001
    s_lshl_b32 s58, s58, 12
    s_add_u32 s59, s59, s58
    s_add_u32 s59, s59, 0x8000
    v_lshl_add_u32 v1, v0, 4, s59
    s_bitcmp1_b32 s6, 0
    s_nop 0
    s_cbranch_scc1 Lm_q1
    ds_write_b128 v1, v[128:131]
    ds_write_b128 v1, v[136:139] offset:1024
    ds_write_b128 v1, v[192:195] offset:2048
    ds_write_b128 v1, v[200:203] offset:3072
    ds_write_b128 v1, v[144:147] offset:8192
    ds_write_b128 v1, v[152:155] offset:9216
    ds_write_b128 v1, v[208:211] offset:10240
    ds_write_b128 v1, v[216:219] offset:11264
    s_branch Lm_q2
Lm_q1:
    ds_write_b128 v1, v[160:163]
    ds_write_b128 v1, v[168:171] offset:1024
    ds_write_b128 v1, v[224:227] offset:2048
    ds_write_b128 v1, v[232:235] offset:3072
    ds_write_b128 v1, v[176:179] offset:8192
    ds_write_b128 v1, v[184:187] offset:9216
    ds_write_b128 v1, v[240:243] offset:10240
    ds_write_b128 v1, v[248:251] offset:11264
Lm_q2:
    s_waitcnt lgkmcnt(0)
    v_mov_b32 v1, 0x24000
    v_mov_b32 v2, 1
    s_mov_b64 exec, 1
    ds_add_u32 v1, v2 offset:72
    s_mov_b64 exec, -1
Lm_noq:
    s_cmp_eq_u32 s4, 1
    s_cselect_b32 s36, s44, s36
    s_cselect_b32 s37, s45, s37
    s_cselect_b32 s38, s46, s38
    s_cselect_b32 s39, s47, s39
    s_cselect_b32 s40, s48, s40
    s_cselect_b32 s41, s49, s41
    s_lshl_b32 s58, s7, 7
    s_add_u32 s58, s58, 0x3c00000
    s_add_u32 s24, s56, s58
    s_addc_u32 s25, s57, 0
    s_lshl_b32 s58, s7, 2
    s_add_u32 s58, s58, s5
    s_lshl_b32 s59, s58, 17
    s_add_u32 s59, s59, 0xa00000
    s_add_u32 s60, s56, s59
    s_addc_u32 s61, s57, 0
    s_mov_b32 s16, s60
    s_and_b32 s17, s61, 0xffff
    s_mov_b32 s18, 0x20000
    s_mov_b32 s19, 0x20000
    s_cmp_ge_u32 s3, 4
    s_cbranch_scc1 Lp_start
    v_lshrrev_b32 v1, 4, v0
    v_and_b32 v22, 15, v0
    v_lshrrev_b32 v24, 5, v0
    v_xor_b32 v25, v24, v22
    v_and_b32 v2, 31, v0
    v_lshlrev_b32 v2, 8, v2
    v_lshl_add_u32 v2, v25, 4, v2
    v_bfe_u32 v25, v0, 2, 2
    v_lshl_add_u32 v3, v24, 2, v25
    v_lshlrev_b32 v3, 8, v3
    v_lshl_add_u32 v3, v25, 6, v3
    v_and_b32 v25, 1, v1
    v_lshl_add_u32 v3, v25, 5, v3
    v_and_b32 v14, 3, v0
    v_lshl_add_u32 v3, v14, 3, v3
    s_and_b32 s60, s3, 1
    s_lshl_b32 s59, s60, 13
    v_lshl_add_u32 v4, v0, 4, s59
    s_lshr_b32 s59, s3, 1
    s_lshl_b32 s59, s59, 14
    s_lshl_b32 s60, s60, 10
    s_add_u32 s59, s59, s60
    s_add_u32 s59, s59, 0x1c000
    v_lshl_add_u32 v5, v0, 4, s59
    v_mov_b32 v9, 0x24000
    v_mov_b32 v80, 0
    v_mov_b32 v81, 0
    v_mov_b32 v82, 0
    v_mov_b32 v83, 0
    v_mov_b32 v84, 0
    v_mov_b32 v85, 0
    v_mov_b32 v86, 0
    v_mov_b32 v87, 0
    v_mov_b32 v88, 0
    v_mov_b32 v89, 0
    v_mov_b32 v90, 0
    v_mov_b32 v91, 0
    v_mov_b32 v92, 0
    v_mov_b32 v93, 0
    v_mov_b32 v94, 0
    v_mov_b32 v95, 0
    v_mov_b32 v96, 0
    v_mov_b32 v97, 0
    v_mov_b32 v98, 0
    v_mov_b32 v99, 0
    v_mov_b32 v100, 0
    v_mov_b32 v101, 0
    v_mov_b32 v102, 0
    v_mov_b32 v103, 0
    v_mov_b32 v104, 0
    v_mov_b32 v105, 0
    v_mov_b32 v106, 0
    v_mov_b32 v107, 0
    v_mov_b32 v108, 0
    v_mov_b32 v109, 0
    v_mov_b32 v110, 0
    v_mov_b32 v111, 0
    v_mov_b32 v112, 0
    v_mov_b32 v113, 0
    v_mov_b32 v114, 0
    v_mov_b32 v115, 0
    v_mov_b32 v116, 0
    v_mov_b32 v117, 0
    v_mov_b32 v118, 0
    v_mov_b32 v119, 0
    v_mov_b32 v120, 0
    v_mov_b32 v121, 0
    v_mov_b32 v122, 0
    v_mov_b32 v123, 0
    v_mov_b32 v124, 0
    v_mov_b32 v125, 0
    v_mov_b32 v126, 0
    v_mov_b32 v127, 0
    v_mov_b32 v128, 0
    v_mov_b32 v129, 0
    v_mov_b32 v130, 0
    v_mov_b32 v131, 0
    v_mov_b32 v132, 0
    v_mov_b32 v133, 0
    v_mov_b32 v134, 0
    v_mov_b32 v135, 0
    v_mov_b32 v136, 0
    v_mov_b32 v137, 0
    v_mov_b32 v138, 0
    v_mov_b32 v139, 0
    v_mov_b32 v140, 0
    v_mov_b32 v141, 0
    v_mov_b32 v142, 0
    v_mov_b32 v143, 0
    v_mov_b32 v7, 0
    v_mov_b32 v8, 0
    v_mov_b32 v10, 0
    v_mov_b32 v11, 0
    s_lshl_b32 s59, s3, 2
    s_add_u32 s59, s59, 0x24000
    v_mov_b32 v12, s59
    s_mov_b32 s29, 0x8000
    s_mov_b32 s30, 0
    s_mov_b32 s31, 0
    ds_read_b128 v[26:29], v9 offset:16
    s_mov_b32 s33, 1
    s_setprio 2
La_unit:
    s_add_u32 s33, s33, 1
    s_waitcnt lgkmcnt(0)
    v_min3_u32 v26, v26, v27, v28
    v_min_u32 v26, v26, v29
    s_nop 0
    v_readfirstlane_b32 s34, v26
    s_nop 1
    s_cmp_lt_u32 s34, s33
    s_cbranch_scc1 Lspin_5
Lback_6:
    s_add_u32 s33, s33, 1
    s_mov_b32 s64, s29
    s_add_u32 s29, s29, 0x4000
    s_cmp_ge_u32 s29, 0x1c000
    s_cselect_b32 s29, 0, s29
    s_cmp_ge_u32 s3, 2
    s_cselect_b32 s64, s29, s64
    v_add_u32 v14, s64, v4
    ds_read_b128 v[48:51], v14
    ds_read_b128 v[52:55], v14 offset:1024
    ds_read_b128 v[56:59], v14 offset:2048
    ds_read_b128 v[60:63], v14 offset:3072
    ds_read_b128 v[64:67], v14 offset:4096
    ds_read_b128 v[68:71], v14 offset:5120
    ds_read_b128 v[72:75], v14 offset:6144
    ds_read_b128 v[76:79], v14 offset:7168
    v_mov_b32 v6, 0
    v_mov_b32 v32, 0
    v_mov_b32 v33, 0
    v_mov_b32 v34, 0
    v_mov_b32 v35, 0
    v_mov_b32 v36, 0
    v_mov_b32 v37, 0
    v_mov_b32 v38, 0
    v_mov_b32 v39, 0
    v_mov_b32 v40, 0
    v_mov_b32 v41, 0
    v_mov_b32 v42, 0
    v_mov_b32 v43, 0
    v_mov_b32 v44, 0
    v_mov_b32 v45, 0
    v_mov_b32 v46, 0
    v_mov_b32 v47, 0
    s_mov_b32 s66, 0xff800000
    s_waitcnt lgkmcnt(0)
    v_add_u32 v11, 2, v11
    s_mov_b64 exec, 1
    ds_write_b32 v12, v11
    s_mov_b64 exec, -1
    ds_read_b128 v[26:29], v9 offset:16
    s_add_u32 s29, s29, 0x4000
    s_cmp_ge_u32 s29, 0x1c000
    s_cselect_b32 s29, 0, s29
    s_mov_b32 s32, 0
La_chunk:
    s_waitcnt lgkmcnt(0)
    v_min3_u32 v26, v26, v27, v28
    v_min_u32 v26, v26, v29
    s_nop 0
    v_readfirstlane_b32 s34, v26
    s_nop 1
    s_cmp_lt_u32 s34, s33
    s_cbranch_scc1 Lspin_7
Lback_8:
    s_add_u32 s33, s33, 1
    v_add_u32 v14, s29, v2
    v_xor_b32 v15, 32, v14
    v_xor_b32 v16, 64, v14
    v_xor_b32 v17, 0x60, v14
    v_xor_b32 v18, 0x80, v14
    v_xor_b32 v19, 0xa0, v14
    v_xor_b32 v20, 0xc0, v14
    v_xor_b32 v21, 0xe0, v14
    ds_read_b128 v[208:211], v14
    ds_read_b128 v[212:215], v14 offset:8192
    ds_read_b128 v[216:219], v15
    ds_read_b128 v[220:223], v15 offset:8192
    ds_read_b128 v[224:227], v16
    ds_read_b128 v[228:231], v16 offset:8192
    ds_read_b128 v[232:235], v17
    s_waitcnt lgkmcnt(6)
    v_mfma_f32_32x32x16_bf16 v[144:159], v[208:211], v[48:51], v[32:47]
    ds_read_b128 v[236:239], v17 offset:8192
    s_waitcnt lgkmcnt(6)
    v_mfma_f32_32x32x16_bf16 v[160:175], v[212:215], v[48:51], v[32:47]
    ds_read_b128 v[208:211], v18
    s_waitcnt lgkmcnt(6)
    v_mfma_f32_32x32x16_bf16 v[144:159], v[216:219], v[52:55], v[144:159]
    ds_read_b128 v[212:215], v18 offset:8192
    s_waitcnt lgkmcnt(6)
    v_mfma_f32_32x32x16_bf16 v[160:175], v[220:223], v[52:55], v[160:175]
    ds_read_b128 v[216:219], v19
    s_waitcnt lgkmcnt(6)
    v_mfma_f32_32x32x16_bf16 v[144:159], v[224:227], v[56:59], v[144:159]
    ds_read_b128 v[220:223], v19 offset:8192
    s_waitcnt lgkmcnt(6)
    v_mfma_f32_32x32x16_bf16 v[160:175], v[228:231], v[56:59], v[160:175]
    ds_read_b128 v[224:227], v20
    s_waitcnt lgkmcnt(6)
    v_mfma_f32_32x32x16_bf16 v[144:159], v[232:235], v[60:63], v[144:159]
    ds_read_b128 v[228:231], v20 offset:8192
    s_waitcnt lgkmcnt(6)
    v_mfma_f32_32x32x16_bf16 v[160:175], v[236:239], v[60:63], v[160:175]
    ds_read_b128 v[232:235], v21
    s_waitcnt lgkmcnt(6)
    v_mfma_f32_32x32x16_bf16 v[144:159], v[208:211], v[64:67], v[144:159]
    ds_read_b128 v[236:239], v21 offset:8192
    s_waitcnt lgkmcnt(6)
    v_mfma_f32_32x32x16_bf16 v[160:175], v[212:215], v[64:67], v[160:175]
    s_waitcnt lgkmcnt(5)
    v_mfma_f32_32x32x16_bf16 v[144:159], v[216:219], v[68:71], v[144:159]
    s_waitcnt lgkmcnt(4)
    v_mfma_f32_32x32x16_bf16 v[160:175], v[220:223], v[68:71], v[160:175]
    s_waitcnt lgkmcnt(3)
    v_mfma_f32_32x32x16_bf16 v[144:159], v[224:227], v[72:75], v[144:159]
    s_waitcnt lgkmcnt(0)
    v_add_u32 v11, 1, v11
    s_mov_b64 exec, 1
    ds_write_b32 v12, v11
    s_mov_b64 exec, -1
    ds_read_b128 v[26:29], v9 offset:16
    s_add_u32 s29, s29, 0x4000
    s_cmp_ge_u32 s29, 0x1c000
    s_cselect_b32 s29, 0, s29
    v_mfma_f32_32x32x16_bf16 v[160:175], v[228:231], v[72:75], v[160:175]
    v_mfma_f32_32x32x16_bf16 v[144:159], v[232:235], v[76:79], v[144:159]
    v_mfma_f32_32x32x16_bf16 v[160:175], v[236:239], v[76:79], v[160:175]
    s_or_b32 s34, s32, s30
    s_cmp_lg_u32 s34, 0
    s_nop 9
    s_cbranch_scc1 Lnos_9
    s_waitcnt vmcnt(0)
    v_mov_b32 v23, 1
    s_mov_b64 exec, 1
    ds_add_rtn_u32 v22, v9, v23 offset:76
    s_mov_b64 exec, -1
    s_waitcnt lgkmcnt(0)
    v_readfirstlane_b32 s34, v22
    s_nop 1
    s_cmp_lg_u32 s34, 7
    s_nop 1
    s_cbranch_scc1 Lsg_10
    s_lshl_b32 s34, s4, 5
    s_lshl_b32 s64, s5, 3
    s_add_u32 s34, s34, s64
    s_lshr_b32 s64, s6, 2
    s_add_u32 s34, s34, s64
    s_lshl_b32 s34, s34, 2
    v_mov_b32 v22, s34
    s_lshl_b32 s34, s4, 2
    s_add_u32 s34, s34, s5
    s_lshl_b32 s34, s34, 2
    v_mov_b32 v24, s34
    v_mov_b32 v25, 0x10000
    s_mov_b64 exec, 1
    global_atomic_add v22, v23, s[54:55]
    global_atomic_add v24, v25, s[54:55]
    s_mov_b64 exec, -1
Lsg_10:
Lnos_9:
    s_waitcnt lgkmcnt(0)
    v_min3_u32 v26, v26, v27, v28
    v_min_u32 v26, v26, v29
    s_nop 0
    v_readfirstlane_b32 s34, v26
    s_nop 1
    s_cmp_lt_u32 s34, s33
    s_cbranch_scc1 Lspin_11
Lback_12:
    s_add_u32 s33, s33, 1
    v_add_u32 v14, s29, v2
    v_xor_b32 v15, 32, v14
    v_xor_b32 v16, 64, v14
    v_xor_b32 v17, 0x60, v14
    v_xor_b32 v18, 0x80, v14
    v_xor_b32 v19, 0xa0, v14
    v_xor_b32 v20, 0xc0, v14
    v_xor_b32 v21, 0xe0, v14
    ds_read_b128 v[208:211], v14
    ds_read_b128 v[212:215], v14 offset:8192
    ds_read_b128 v[216:219], v15
    ds_read_b128 v[220:223], v15 offset:8192
    ds_read_b128 v[224:227], v16
    ds_read_b128 v[228:231], v16 offset:8192
    ds_read_b128 v[232:235], v17
    s_waitcnt lgkmcnt(6)
    v_mfma_f32_32x32x16_bf16 v[176:191], v[208:211], v[48:51], v[32:47]
    ds_read_b128 v[236:239], v17 offset:8192
    s_waitcnt lgkmcnt(6)
    v_mfma_f32_32x32x16_bf16 v[192:207], v[212:215], v[48:51], v[32:47]
    ds_read_b128 v[208:211], v18
    s_waitcnt lgkmcnt(6)
    v_mfma_f32_32x32x16_bf16 v[176:191], v[216:219], v[52:55], v[176:191]
    ds_read_b128 v[212:215], v18 offset:8192
    s_waitcnt lgkmcnt(6)
    v_mfma_f32_32x32x16_bf16 v[192:207], v[220:223], v[52:55], v[192:207]
    ds_read_b128 v[216:219], v19
    s_waitcnt lgkmcnt(6)
    v_mfma_f32_32x32x16_bf16 v[176:191], v[224:227], v[56:59], v[176:191]
    ds_read_b128 v[220:223], v19 offset:8192
    s_waitcnt lgkmcnt(6)
    v_mfma_f32_32x32x16_bf16 v[192:207], v[228:231], v[56:59], v[192:207]
    ds_read_b128 v[224:227], v20
    s_waitcnt lgkmcnt(6)
    v_mfma_f32_32x32x16_bf16 v[176:191], v[232:235], v[60:63], v[176:191]
    ds_read_b128 v[228:231], v20 offset:8192
    s_waitcnt lgkmcnt(6)
    v_mfma_f32_32x32x16_bf16 v[192:207], v[236:239], v[60:63], v[192:207]
    ds_read_b128 v[232:235], v21
    s_waitcnt lgkmcnt(6)
    v_mfma_f32_32x32x16_bf16 v[176:191], v[208:211], v[64:67], v[176:191]
    ds_read_b128 v[236:239], v21 offset:8192
    s_waitcnt lgkmcnt(6)
    v_mfma_f32_32x32x16_bf16 v[192:207], v[212:215], v[64:67], v[192:207]
    s_waitcnt lgkmcnt(5)
    v_mfma_f32_32x32x16_bf16 v[176:191], v[216:219], v[68:71], v[176:191]
    s_waitcnt lgkmcnt(4)
    v_mfma_f32_32x32x16_bf16 v[192:207], v[220:223], v[68:71], v[192:207]
    s_waitcnt lgkmcnt(3)
    v_mfma_f32_32x32x16_bf16 v[176:191], v[224:227], v[72:75], v[176:191]
    s_waitcnt lgkmcnt(0)
    v_add_u32 v11, 1, v11
    s_mov_b64 exec, 1
    ds_write_b32 v12, v11
    s_mov_b64 exec, -1
    ds_read_b128 v[26:29], v9 offset:16
    s_add_u32 s29, s29, 0x4000
    s_cmp_ge_u32 s29, 0x1c000
    s_cselect_b32 s29, 0, s29
    v_mfma_f32_32x32x16_bf16 v[192:207], v[228:231], v[72:75], v[192:207]
    v_mfma_f32_32x32x16_bf16 v[176:191], v[232:235], v[76:79], v[176:191]
    v_mfma_f32_32x32x16_bf16 v[192:207], v[236:239], v[76:79], v[192:207]
    s_waitcnt lgkmcnt(0)
    v_min3_u32 v26, v26, v27, v28
    v_min_u32 v26, v26, v29
    s_nop 0
    v_readfirstlane_b32 s34, v26
    s_nop 1
    s_cmp_lt_u32 s34, s33
    s_cbranch_scc1 Lspin_13
Lback_14:
    s_add_u32 s33, s33, 1
    v_add_u32 v14, s29, v3
    v_xor_b32 v15, 64, v14
    v_xor_b32 v16, 0x80, v14
    v_xor_b32 v17, 0xc0, v14
    ds_read_b64_tr_b16 v[208:209], v14
    ds_read_b64_tr_b16 v[210:211], v14 offset:2048
    ds_read_b64_tr_b16 v[212:213], v15
    ds_read_b64_tr_b16 v[214:215], v15 offset:2048
    ds_read_b64_tr_b16 v[216:217], v16
    ds_read_b64_tr_b16 v[218:219], v16 offset:2048
    ds_read_b64_tr_b16 v[220:221], v17
    ds_read_b64_tr_b16 v[222:223], v17 offset:2048
    ds_read_b64_tr_b16 v[224:225], v14 offset:4096
    ds_read_b64_tr_b16 v[226:227], v14 offset:6144
    ds_read_b64_tr_b16 v[228:229], v15 offset:4096
    ds_read_b64_tr_b16 v[230:231], v15 offset:6144
    ds_read_b64_tr_b16 v[232:233], v16 offset:4096
    ds_read_b64_tr_b16 v[234:235], v16 offset:6144
    v_max3_f32 v22, v144, v145, v146
    v_max3_f32 v23, v147, v148, v149
    v_max3_f32 v22, v22, v150, v151
    v_max3_f32 v23, v23, v152, v153
    v_max3_f32 v22, v22, v154, v155
    v_max3_f32 v23, v23, v156, v157
    v_max3_f32 v22, v22, v158, v159
    v_max3_f32 v23, v23, v160, v161
    v_max3_f32 v22, v22, v162, v163
    v_max3_f32 v23, v23, v164, v165
    v_max3_f32 v22, v22, v166, v167
    v_max3_f32 v23, v23, v168, v169
    v_max3_f32 v22, v22, v170, v171
    v_max3_f32 v23, v23, v172, v173
    v_max3_f32 v22, v22, v174, v175
    v_max3_f32 v23, v23, v176, v177
    v_max3_f32 v22, v22, v178, v179
    v_max3_f32 v23, v23, v180, v181
    v_max3_f32 v22, v22, v182, v183
    v_max3_f32 v23, v23, v184, v185
    v_max3_f32 v22, v22, v186, v187
    v_max3_f32 v23, v23, v188, v189
    v_max3_f32 v22, v22, v190, v191
    v_max3_f32 v23, v23, v192, v193
    v_max3_f32 v22, v22, v194, v195
    v_max3_f32 v23, v23, v196, v197
    v_max3_f32 v22, v22, v198, v199
    v_max3_f32 v23, v23, v200, v201
    v_max3_f32 v22, v22, v202, v203
    v_max3_f32 v23, v23, v204, v205
    v_max3_f32 v22, v22, v206, v207
    v_max_f32 v22, v22, v23
    v_mov_b32 v23, v22
    s_nop 1
    v_permlane32_swap_b32 v22, v23
    v_max_f32 v22, v22, v23
    v_cmp_lt_f32 vcc, s66, v22
    s_nop 4
    s_cbranch_vccz Lfast_15
    v_max_f32 v23, s66, v22
    v_max_f32 v24, 0, v22
    s_cmp_eq_u32 s32, 0
    s_cselect_b64 vcc, -1, 0
    v_cndmask_b32 v22, v24, v22, vcc
    v_sub_f32 v23, 0, v22
    v_exp_f32 v23, v23
    s_nop 0
    v_cndmask_b32 v23, v23, 0, vcc
    v_add_f32 v6, v6, v22
    v_mul_f32 v7, v7, v23
    v_mul_f32 v8, v8, v23
    v_sub_f32 v144, v144, v22
    v_sub_f32 v145, v145, v22
    v_sub_f32 v146, v146, v22
    v_sub_f32 v147, v147, v22
    v_sub_f32 v148, v148, v22
    v_sub_f32 v149, v149, v22
    v_sub_f32 v150, v150, v22
    v_sub_f32 v151, v151, v22
    v_sub_f32 v152, v152, v22
    v_sub_f32 v153, v153, v22
    v_sub_f32 v154, v154, v22
    v_sub_f32 v155, v155, v22
    v_sub_f32 v156, v156, v22
    v_sub_f32 v157, v157, v22
    v_sub_f32 v158, v158, v22
    v_sub_f32 v159, v159, v22
    v_sub_f32 v160, v160, v22
    v_sub_f32 v161, v161, v22
    v_sub_f32 v162, v162, v22
    v_sub_f32 v163, v163, v22
    v_sub_f32 v164, v164, v22
    v_sub_f32 v165, v165, v22
    v_sub_f32 v166, v166, v22
    v_sub_f32 v167, v167, v22
    v_sub_f32 v168, v168, v22
    v_sub_f32 v169, v169, v22
    v_sub_f32 v170, v170, v22
    v_sub_f32 v171, v171, v22
    v_sub_f32 v172, v172, v22
    v_sub_f32 v173, v173, v22
    v_sub_f32 v174, v174, v22
    v_sub_f32 v175, v175, v22
    v_sub_f32 v176, v176, v22
    v_sub_f32 v177, v177, v22
    v_sub_f32 v178, v178, v22
    v_sub_f32 v179, v179, v22
    v_sub_f32 v180, v180, v22
    v_sub_f32 v181, v181, v22
    v_sub_f32 v182, v182, v22
    v_sub_f32 v183, v183, v22
    v_sub_f32 v184, v184, v22
    v_sub_f32 v185, v185, v22
    v_sub_f32 v186, v186, v22
    v_sub_f32 v187, v187, v22
    v_sub_f32 v188, v188, v22
    v_sub_f32 v189, v189, v22
    v_sub_f32 v190, v190, v22
    v_sub_f32 v191, v191, v22
    v_sub_f32 v192, v192, v22
    v_sub_f32 v193, v193, v22
    v_sub_f32 v194, v194, v22
    v_sub_f32 v195, v195, v22
    v_sub_f32 v196, v196, v22
    v_sub_f32 v197, v197, v22
    v_sub_f32 v198, v198, v22
    v_sub_f32 v199, v199, v22
    v_sub_f32 v200, v200, v22
    v_sub_f32 v201, v201, v22
    v_sub_f32 v202, v202, v22
    v_sub_f32 v203, v203, v22
    v_sub_f32 v204, v204, v22
    v_sub_f32 v205, v205, v22
    v_sub_f32 v206, v206, v22
    v_sub_f32 v207, v207, v22
    v_mul_f32 v80, v80, v23
    v_mul_f32 v81, v81, v23
    v_mul_f32 v82, v82, v23
    v_mul_f32 v83, v83, v23
    v_mul_f32 v84, v84, v23
    v_mul_f32 v85, v85, v23
    v_mul_f32 v86, v86, v23
    v_mul_f32 v87, v87, v23
    v_mul_f32 v88, v88, v23
    v_mul_f32 v89, v89, v23
    v_mul_f32 v90, v90, v23
    v_mul_f32 v91, v91, v23
    v_mul_f32 v92, v92, v23
    v_mul_f32 v93, v93, v23
    v_mul_f32 v94, v94, v23
    v_mul_f32 v95, v95, v23
    v_mul_f32 v96, v96, v23
    v_mul_f32 v97, v97, v23
    v_mul_f32 v98, v98, v23
    v_mul_f32 v99, v99, v23
    v_mul_f32 v100, v100, v23
    v_mul_f32 v101, v101, v23
    v_mul_f32 v102, v102, v23
    v_mul_f32 v103, v103, v23
    v_mul_f32 v104, v104, v23
    v_mul_f32 v105, v105, v23
    v_mul_f32 v106, v106, v23
    v_mul_f32 v107, v107, v23
    v_mul_f32 v108, v108, v23
    v_mul_f32 v109, v109, v23
    v_mul_f32 v110, v110, v23
    v_mul_f32 v111, v111, v23
    v_mul_f32 v112, v112, v23
    v_mul_f32 v113, v113, v23
    v_mul_f32 v114, v114, v23
    v_mul_f32 v115, v115, v23
    v_mul_f32 v116, v116, v23
    v_mul_f32 v117, v117, v23
    v_mul_f32 v118, v118, v23
    v_mul_f32 v119, v119, v23
    v_mul_f32 v120, v120, v23
    v_mul_f32 v121, v121, v23
    v_mul_f32 v122, v122, v23
    v_mul_f32 v123, v123, v23
    v_mul_f32 v124, v124, v23
    v_mul_f32 v125, v125, v23
    v_mul_f32 v126, v126, v23
    v_mul_f32 v127, v127, v23
    v_mul_f32 v128, v128, v23
    v_mul_f32 v129, v129, v23
    v_mul_f32 v130, v130, v23
    v_mul_f32 v131, v131, v23
    v_mul_f32 v132, v132, v23
    v_mul_f32 v133, v133, v23
    v_mul_f32 v134, v134, v23
    v_mul_f32 v135, v135, v23
    v_mul_f32 v136, v136, v23
    v_mul_f32 v137, v137, v23
    v_mul_f32 v138, v138, v23
    v_mul_f32 v139, v139, v23
    v_mul_f32 v140, v140, v23
    v_mul_f32 v141, v141, v23
    v_mul_f32 v142, v142, v23
    v_mul_f32 v143, v143, v23
    v_sub_f32 v32, 0, v6
    v_mov_b32 v33, v32
    v_mov_b32 v34, v32
    v_mov_b32 v35, v32
    v_mov_b32 v36, v32
    v_mov_b32 v37, v32
    v_mov_b32 v38, v32
    v_mov_b32 v39, v32
    v_mov_b32 v40, v32
    v_mov_b32 v41, v32
    v_mov_b32 v42, v32
    v_mov_b32 v43, v32
    v_mov_b32 v44, v32
    v_mov_b32 v45, v32
    v_mov_b32 v46, v32
    v_mov_b32 v47, v32
    s_mov_b32 s66, 0x41000000
    s_nop 0
Lfast_15:
    v_exp_f32 v144, v144
    v_exp_f32 v145, v145
    v_exp_f32 v146, v146
    v_exp_f32 v147, v147
    v_add_f32 v7, v7, v144
    v_add_f32 v8, v8, v145
    v_cvt_pk_bf16_f32 v144, v144, v145
    v_exp_f32 v148, v148
    v_exp_f32 v149, v149
    v_add_f32 v7, v7, v146
    v_add_f32 v8, v8, v147
    v_cvt_pk_bf16_f32 v145, v146, v147
    v_exp_f32 v150, v150
    v_exp_f32 v151, v151
    v_add_f32 v7, v7, v148
    v_add_f32 v8, v8, v149
    v_cvt_pk_bf16_f32 v146, v148, v149
    v_exp_f32 v152, v152
    v_exp_f32 v153, v153
    v_add_f32 v7, v7, v150
    v_add_f32 v8, v8, v151
    v_cvt_pk_bf16_f32 v147, v150, v151
    v_exp_f32 v154, v154
    v_exp_f32 v155, v155
    v_add_f32 v7, v7, v152
    v_add_f32 v8, v8, v153
    v_cvt_pk_bf16_f32 v148, v152, v153
    v_exp_f32 v156, v156
    v_exp_f32 v157, v157
    v_add_f32 v7, v7, v154
    v_add_f32 v8, v8, v155
    v_cvt_pk_bf16_f32 v149, v154, v155
    v_exp_f32 v158, v158
    v_exp_f32 v159, v159
    v_add_f32 v7, v7, v156
    v_add_f32 v8, v8, v157
    v_cvt_pk_bf16_f32 v150, v156, v157
    v_exp_f32 v160, v160
    v_exp_f32 v161, v161
    v_add_f32 v7, v7, v158
    v_add_f32 v8, v8, v159
    v_cvt_pk_bf16_f32 v151, v158, v159
    v_exp_f32 v162, v162
    v_exp_f32 v163, v163
    v_add_f32 v7, v7, v160
    v_add_f32 v8, v8, v161
    v_cvt_pk_bf16_f32 v152, v160, v161
    v_exp_f32 v164, v164
    v_exp_f32 v165, v165
    v_add_f32 v7, v7, v162
    v_add_f32 v8, v8, v163
    v_cvt_pk_bf16_f32 v153, v162, v163
    v_exp_f32 v166, v166
    v_exp_f32 v167, v167
    v_add_f32 v7, v7, v164
    v_add_f32 v8, v8, v165
    v_cvt_pk_bf16_f32 v154, v164, v165
    v_exp_f32 v168, v168
    v_exp_f32 v169, v169
    v_add_f32 v7, v7, v166
    v_add_f32 v8, v8, v167
    v_cvt_pk_bf16_f32 v155, v166, v167
    v_exp_f32 v170, v170
    v_exp_f32 v171, v171
    v_add_f32 v7, v7, v168
    v_add_f32 v8, v8, v169
    v_cvt_pk_bf16_f32 v156, v168, v169
    v_exp_f32 v172, v172
    v_exp_f32 v173, v173
    v_add_f32 v7, v7, v170
    v_add_f32 v8, v8, v171
    v_cvt_pk_bf16_f32 v157, v170, v171
    v_exp_f32 v174, v174
    v_exp_f32 v175, v175
    v_add_f32 v7, v7, v172
    v_add_f32 v8, v8, v173
    v_cvt_pk_bf16_f32 v158, v172, v173
    v_exp_f32 v176, v176
    v_exp_f32 v177, v177
    v_add_f32 v7, v7, v174
    v_add_f32 v8, v8, v175
    v_cvt_pk_bf16_f32 v159, v174, v175
    v_exp_f32 v178, v178
    v_exp_f32 v179, v179
    v_add_f32 v7, v7, v176
    v_add_f32 v8, v8, v177
    v_cvt_pk_bf16_f32 v160, v176, v177
    v_exp_f32 v180, v180
    v_exp_f32 v181, v181
    v_add_f32 v7, v7, v178
    v_add_f32 v8, v8, v179
    v_cvt_pk_bf16_f32 v161, v178, v179
    v_exp_f32 v182, v182
    v_exp_f32 v183, v183
    v_add_f32 v7, v7, v180
    v_add_f32 v8, v8, v181
    v_cvt_pk_bf16_f32 v162, v180, v181
    v_exp_f32 v184, v184
    v_exp_f32 v185, v185
    v_add_f32 v7, v7, v182
    v_add_f32 v8, v8, v183
    v_cvt_pk_bf16_f32 v163, v182, v183
    v_exp_f32 v186, v186
    v_exp_f32 v187, v187
    v_add_f32 v7, v7, v184
    v_add_f32 v8, v8, v185
    v_cvt_pk_bf16_f32 v164, v184, v185
    v_exp_f32 v188, v188
    v_exp_f32 v189, v189
    v_add_f32 v7, v7, v186
    v_add_f32 v8, v8, v187
    v_cvt_pk_bf16_f32 v165, v186, v187
    v_exp_f32 v190, v190
    v_exp_f32 v191, v191
    v_add_f32 v7, v7, v188
    v_add_f32 v8, v8, v189
    v_cvt_pk_bf16_f32 v166, v188, v189
    v_exp_f32 v192, v192
    v_exp_f32 v193, v193
    v_add_f32 v7, v7, v190
    v_add_f32 v8, v8, v191
    v_cvt_pk_bf16_f32 v167, v190, v191
    v_exp_f32 v194, v194
    v_exp_f32 v195, v195
    v_add_f32 v7, v7, v192
    v_add_f32 v8, v8, v193
    v_cvt_pk_bf16_f32 v168, v192, v193
    v_exp_f32 v196, v196
    v_exp_f32 v197, v197
    v_add_f32 v7, v7, v194
    v_add_f32 v8, v8, v195
    v_cvt_pk_bf16_f32 v169, v194, v195
    v_exp_f32 v198, v198
    v_exp_f32 v199, v199
    v_add_f32 v7, v7, v196
    v_add_f32 v8, v8, v197
    v_cvt_pk_bf16_f32 v170, v196, v197
    v_exp_f32 v200, v200
    v_exp_f32 v201, v201
    v_add_f32 v7, v7, v198
    v_add_f32 v8, v8, v199
    v_cvt_pk_bf16_f32 v171, v198, v199
    v_exp_f32 v202, v202
    v_exp_f32 v203, v203
    v_add_f32 v7, v7, v200
    v_add_f32 v8, v8, v201
    v_cvt_pk_bf16_f32 v172, v200, v201
    v_exp_f32 v204, v204
    v_exp_f32 v205, v205
    v_add_f32 v7, v7, v202
    v_add_f32 v8, v8, v203
    v_cvt_pk_bf16_f32 v173, v202, v203
    v_exp_f32 v206, v206
    v_exp_f32 v207, v207
    v_add_f32 v7, v7, v204
    v_add_f32 v8, v8, v205
    v_cvt_pk_bf16_f32 v174, v204, v205
    v_add_f32 v7, v7, v206
    v_add_f32 v8, v8, v207
    v_cvt_pk_bf16_f32 v175, v206, v207
    s_waitcnt lgkmcnt(12)
    v_mfma_f32_32x32x16_bf16 v[80:95], v[208:211], v[144:147], v[80:95]
    ds_read_b64_tr_b16 v[236:237], v17 offset:4096
    ds_read_b64_tr_b16 v[238:239], v17 offset:6144
    s_waitcnt lgkmcnt(12)
    v_mfma_f32_32x32x16_bf16 v[96:111], v[212:215], v[144:147], v[96:111]
    ds_read_b64_tr_b16 v[208:209], v14 offset:8192
    ds_read_b64_tr_b16 v[210:211], v14 offset:10240
    s_waitcnt lgkmcnt(12)
    v_mfma_f32_32x32x16_bf16 v[112:127], v[216:219], v[144:147], v[112:127]
    ds_read_b64_tr_b16 v[212:213], v15 offset:8192
    ds_read_b64_tr_b16 v[214:215], v15 offset:10240
    s_waitcnt lgkmcnt(12)
    v_mfma_f32_32x32x16_bf16 v[128:143], v[220:223], v[144:147], v[128:143]
    ds_read_b64_tr_b16 v[216:217], v16 offset:8192
    ds_read_b64_tr_b16 v[218:219], v16 offset:10240
    s_waitcnt lgkmcnt(12)
    v_mfma_f32_32x32x16_bf16 v[80:95], v[224:227], v[148:151], v[80:95]
    ds_read_b64_tr_b16 v[220:221], v17 offset:8192
    ds_read_b64_tr_b16 v[222:223], v17 offset:10240
    s_waitcnt lgkmcnt(12)
    v_mfma_f32_32x32x16_bf16 v[96:111], v[228:231], v[148:151], v[96:111]
    ds_read_b64_tr_b16 v[224:225], v14 offset:12288
    ds_read_b64_tr_b16 v[226:227], v14 offset:14336
    s_waitcnt lgkmcnt(12)
    v_mfma_f32_32x32x16_bf16 v[112:127], v[232:235], v[148:151], v[112:127]
    ds_read_b64_tr_b16 v[228:229], v15 offset:12288
    ds_read_b64_tr_b16 v[230:231], v15 offset:14336
    s_waitcnt lgkmcnt(12)
    v_mfma_f32_32x32x16_bf16 v[128:143], v[236:239], v[148:151], v[128:143]
    ds_read_b64_tr_b16 v[232:233], v16 offset:12288
    ds_read_b64_tr_b16 v[234:235], v16 offset:14336
    s_waitcnt lgkmcnt(12)
    v_mfma_f32_32x32x16_bf16 v[80:95], v[208:211], v[152:155], v[80:95]
    ds_read_b64_tr_b16 v[236:237], v17 offset:12288
    ds_read_b64_tr_b16 v[238:239], v17 offset:14336
    s_waitcnt lgkmcnt(12)
    v_mfma_f32_32x32x16_bf16 v[96:111], v[212:215], v[152:155], v[96:111]
    s_waitcnt lgkmcnt(10)
    v_mfma_f32_32x32x16_bf16 v[112:127], v[216:219], v[152:155], v[112:127]
    s_waitcnt lgkmcnt(8)
    v_mfma_f32_32x32x16_bf16 v[128:143], v[220:223], v[152:155], v[128:143]
    s_waitcnt lgkmcnt(6)
    v_mfma_f32_32x32x16_bf16 v[80:95], v[224:227], v[156:159], v[80:95]
    s_waitcnt lgkmcnt(0)
    v_add_u32 v11, 1, v11
    s_mov_b64 exec, 1
    ds_write_b32 v12, v11
    s_mov_b64 exec, -1
    ds_read_b128 v[26:29], v9 offset:16
    s_add_u32 s29, s29, 0x4000
    s_cmp_ge_u32 s29, 0x1c000
    s_cselect_b32 s29, 0, s29
    v_mfma_f32_32x32x16_bf16 v[96:111], v[228:231], v[156:159], v[96:111]
    v_mfma_f32_32x32x16_bf16 v[112:127], v[232:235], v[156:159], v[112:127]
    v_mfma_f32_32x32x16_bf16 v[128:143], v[236:239], v[156:159], v[128:143]
    s_waitcnt lgkmcnt(0)
    v_min3_u32 v26, v26, v27, v28
    v_min_u32 v26, v26, v29
    s_nop 0
    v_readfirstlane_b32 s34, v26
    s_nop 1
    s_cmp_lt_u32 s34, s33
    s_cbranch_scc1 Lspin_16
Lback_17:
    s_add_u32 s33, s33, 1
    v_add_u32 v14, s29, v3
    v_xor_b32 v15, 64, v14
    v_xor_b32 v16, 0x80, v14
    v_xor_b32 v17, 0xc0, v14
    ds_read_b64_tr_b16 v[208:209], v14
    ds_read_b64_tr_b16 v[210:211], v14 offset:2048
    ds_read_b64_tr_b16 v[212:213], v15
    ds_read_b64_tr_b16 v[214:215], v15 offset:2048
    ds_read_b64_tr_b16 v[216:217], v16
    ds_read_b64_tr_b16 v[218:219], v16 offset:2048
    ds_read_b64_tr_b16 v[220:221], v17
    ds_read_b64_tr_b16 v[222:223], v17 offset:2048
    ds_read_b64_tr_b16 v[224:225], v14 offset:4096
    ds_read_b64_tr_b16 v[226:227], v14 offset:6144
    ds_read_b64_tr_b16 v[228:229], v15 offset:4096
    ds_read_b64_tr_b16 v[230:231], v15 offset:6144
    ds_read_b64_tr_b16 v[232:233], v16 offset:4096
    ds_read_b64_tr_b16 v[234:235], v16 offset:6144
    s_waitcnt lgkmcnt(12)
    v_mfma_f32_32x32x16_bf16 v[80:95], v[208:211], v[160:163], v[80:95]
    ds_read_b64_tr_b16 v[236:237], v17 offset:4096
    ds_read_b64_tr_b16 v[238:239], v17 offset:6144
    s_waitcnt lgkmcnt(12)
    v_mfma_f32_32x32x16_bf16 v[96:111], v[212:215], v[160:163], v[96:111]
    ds_read_b64_tr_b16 v[208:209], v14 offset:8192
    ds_read_b64_tr_b16 v[210:211], v14 offset:10240
    s_waitcnt lgkmcnt(12)
    v_mfma_f32_32x32x16_bf16 v[112:127], v[216:219], v[160:163], v[112:127]
    ds_read_b64_tr_b16 v[212:213], v15 offset:8192
    ds_read_b64_tr_b16 v[214:215], v15 offset:10240
    s_waitcnt lgkmcnt(12)
    v_mfma_f32_32x32x16_bf16 v[128:143], v[220:223], v[160:163], v[128:143]
    ds_read_b64_tr_b16 v[216:217], v16 offset:8192
    ds_read_b64_tr_b16 v[218:219], v16 offset:10240
    s_waitcnt lgkmcnt(12)
    v_mfma_f32_32x32x16_bf16 v[80:95], v[224:227], v[164:167], v[80:95]
    ds_read_b64_tr_b16 v[220:221], v17 offset:8192
    ds_read_b64_tr_b16 v[222:223], v17 offset:10240
    s_waitcnt lgkmcnt(12)
    v_mfma_f32_32x32x16_bf16 v[96:111], v[228:231], v[164:167], v[96:111]
    ds_read_b64_tr_b16 v[224:225], v14 offset:12288
    ds_read_b64_tr_b16 v[226:227], v14 offset:14336
    s_waitcnt lgkmcnt(12)
    v_mfma_f32_32x32x16_bf16 v[112:127], v[232:235], v[164:167], v[112:127]
    ds_read_b64_tr_b16 v[228:229], v15 offset:12288
    ds_read_b64_tr_b16 v[230:231], v15 offset:14336
    s_waitcnt lgkmcnt(12)
    v_mfma_f32_32x32x16_bf16 v[128:143], v[236:239], v[164:167], v[128:143]
    ds_read_b64_tr_b16 v[232:233], v16 offset:12288
    ds_read_b64_tr_b16 v[234:235], v16 offset:14336
    s_waitcnt lgkmcnt(12)
    v_mfma_f32_32x32x16_bf16 v[80:95], v[208:211], v[168:171], v[80:95]
    ds_read_b64_tr_b16 v[236:237], v17 offset:12288
    ds_read_b64_tr_b16 v[238:239], v17 offset:14336
    s_waitcnt lgkmcnt(12)
    v_mfma_f32_32x32x16_bf16 v[96:111], v[212:215], v[168:171], v[96:111]
    s_waitcnt lgkmcnt(10)
    v_mfma_f32_32x32x16_bf16 v[112:127], v[216:219], v[168:171], v[112:127]
    s_waitcnt lgkmcnt(8)
    v_mfma_f32_32x32x16_bf16 v[128:143], v[220:223], v[168:171], v[128:143]
    s_waitcnt lgkmcnt(6)
    v_mfma_f32_32x32x16_bf16 v[80:95], v[224:227], v[172:175], v[80:95]
    s_waitcnt lgkmcnt(0)
    v_add_u32 v11, 1, v11
    s_mov_b64 exec, 1
    ds_write_b32 v12, v11
    s_mov_b64 exec, -1
    ds_read_b128 v[26:29], v9 offset:16
    s_add_u32 s29, s29, 0x4000
    s_cmp_ge_u32 s29, 0x1c000
    s_cselect_b32 s29, 0, s29
    v_mfma_f32_32x32x16_bf16 v[96:111], v[228:231], v[172:175], v[96:111]
    v_mfma_f32_32x32x16_bf16 v[112:127], v[232:235], v[172:175], v[112:127]
    v_mfma_f32_32x32x16_bf16 v[128:143], v[236:239], v[172:175], v[128:143]
    s_add_u32 s32, s32, 1
    s_cmp_lt_u32 s32, 4
    s_nop 9
    s_cbranch_scc1 La_chunk
    s_waitcnt lgkmcnt(0)
    ds_read_b128 v[14:17], v9 offset:48
    v_add_f32 v22, v7, v8
    v_mov_b32 v23, v22
    s_nop 1
    v_permlane32_swap_b32 v22, v23
    v_add_f32 v22, v22, v23
    v_rcp_f32 v22, v22
    s_nop 0
    v_mul_f32 v80, v80, v22
    v_mul_f32 v81, v81, v22
    v_mul_f32 v82, v82, v22
    v_mul_f32 v83, v83, v22
    v_mul_f32 v84, v84, v22
    v_mul_f32 v85, v85, v22
    v_mul_f32 v86, v86, v22
    v_mul_f32 v87, v87, v22
    v_cvt_pk_bf16_f32 v144, v80, v81
    v_cvt_pk_bf16_f32 v145, v82, v83
    v_cvt_pk_bf16_f32 v146, v84, v85
    v_cvt_pk_bf16_f32 v147, v86, v87
    v_mul_f32 v88, v88, v22
    v_mul_f32 v89, v89, v22
    v_mul_f32 v90, v90, v22
    v_mul_f32 v91, v91, v22
    v_mul_f32 v92, v92, v22
    v_mul_f32 v93, v93, v22
    v_mul_f32 v94, v94, v22
    v_mul_f32 v95, v95, v22
    v_cvt_pk_bf16_f32 v148, v88, v89
    v_cvt_pk_bf16_f32 v149, v90, v91
    v_cvt_pk_bf16_f32 v150, v92, v93
    v_cvt_pk_bf16_f32 v151, v94, v95
    v_mul_f32 v96, v96, v22
    v_mul_f32 v97, v97, v22
    v_mul_f32 v98, v98, v22
    v_mul_f32 v99, v99, v22
    v_mul_f32 v100, v100, v22
    v_mul_f32 v101, v101, v22
    v_mul_f32 v102, v102, v22
    v_mul_f32 v103, v103, v22
    v_cvt_pk_bf16_f32 v152, v96, v97
    v_cvt_pk_bf16_f32 v153, v98, v99
    v_cvt_pk_bf16_f32 v154, v100, v101
    v_cvt_pk_bf16_f32 v155, v102, v103
    v_mul_f32 v104, v104, v22
    v_mul_f32 v105, v105, v22
    v_mul_f32 v106, v106, v22
    v_mul_f32 v107, v107, v22
    v_mul_f32 v108, v108, v22
    v_mul_f32 v109, v109, v22
    v_mul_f32 v110, v110, v22
    v_mul_f32 v111, v111, v22
    v_cvt_pk_bf16_f32 v156, v104, v105
    v_cvt_pk_bf16_f32 v157, v106, v107
    v_cvt_pk_bf16_f32 v158, v108, v109
    v_cvt_pk_bf16_f32 v159, v110, v111
    v_mul_f32 v112, v112, v22
    v_mul_f32 v113, v113, v22
    v_mul_f32 v114, v114, v22
    v_mul_f32 v115, v115, v22
    v_mul_f32 v116, v116, v22
    v_mul_f32 v117, v117, v22
    v_mul_f32 v118, v118, v22
    v_mul_f32 v119, v119, v22
    v_cvt_pk_bf16_f32 v160, v112, v113
    v_cvt_pk_bf16_f32 v161, v114, v115
    v_cvt_pk_bf16_f32 v162, v116, v117
    v_cvt_pk_bf16_f32 v163, v118, v119
    v_mul_f32 v120, v120, v22
    v_mul_f32 v121, v121, v22
    v_mul_f32 v122, v122, v22
    v_mul_f32 v123, v123, v22
    v_mul_f32 v124, v124, v22
    v_mul_f32 v125, v125, v22
    v_mul_f32 v126, v126, v22
    v_mul_f32 v127, v127, v22
    v_cvt_pk_bf16_f32 v164, v120, v121
    v_cvt_pk_bf16_f32 v165, v122, v123
    v_cvt_pk_bf16_f32 v166, v124, v125
    v_cvt_pk_bf16_f32 v167, v126, v127
    v_mul_f32 v128, v128, v22
    v_mul_f32 v129, v129, v22
    v_mul_f32 v130, v130, v22
    v_mul_f32 v131, v131, v22
    v_mul_f32 v132, v132, v22
    v_mul_f32 v133, v133, v22
    v_mul_f32 v134, v134, v22
    v_mul_f32 v135, v135, v22
    v_cvt_pk_bf16_f32 v168, v128, v129
    v_cvt_pk_bf16_f32 v169, v130, v131
    v_cvt_pk_bf16_f32 v170, v132, v133
    v_cvt_pk_bf16_f32 v171, v134, v135
    v_mul_f32 v136, v136, v22
    v_mul_f32 v137, v137, v22
    v_mul_f32 v138, v138, v22
    v_mul_f32 v139, v139, v22
    v_mul_f32 v140, v140, v22
    v_mul_f32 v141, v141, v22
    v_mul_f32 v142, v142, v22
    v_mul_f32 v143, v143, v22
    v_cvt_pk_bf16_f32 v172, v136, v137
    v_cvt_pk_bf16_f32 v173, v138, v139
    v_cvt_pk_bf16_f32 v174, v140, v141
    v_cvt_pk_bf16_f32 v175, v142, v143
    s_waitcnt lgkmcnt(0)
    v_min3_u32 v14, v14, v15, v16
    v_min_u32 v14, v14, v17
    s_nop 0
    v_readfirstlane_b32 s34, v14
    s_nop 1
    s_cmp_lt_u32 s34, s30
    s_cbranch_scc1 Lspin_18
Lback_19:
    ds_write_b128 v5, v[144:147]
    ds_write_b128 v5, v[148:151] offset:2048
    ds_write_b128 v5, v[152:155] offset:4096
    ds_write_b128 v5, v[156:159] offset:6144
    ds_write_b128 v5, v[160:163] offset:8192
    ds_write_b128 v5, v[164:167] offset:10240
    ds_write_b128 v5, v[168:171] offset:12288
    ds_write_b128 v5, v[172:175] offset:14336
    s_waitcnt lgkmcnt(0)
    v_add_u32 v24, 32, v12
    v_add_u32 v10, 1, v10
    s_mov_b64 exec, 1
    ds_write_b32 v24, v10
    s_mov_b64 exec, -1
    s_add_u32 s30, s30, 1
    s_cmp_lt_u32 s30, 4
    s_cbranch_scc1 La_unit
    s_waitcnt lgkmcnt(0)
    s_branch Lm_done
Lspin_5:
    s_mov_b32 s63, 0
Lspin_5_l:
    s_sleep 1
    ds_read_b128 v[26:29], v9 offset:16
    s_waitcnt lgkmcnt(0)
    v_min3_u32 v26, v26, v27, v28
    v_min_u32 v26, v26, v29
    s_nop 0
    v_readfirstlane_b32 s34, v26
    s_nop 1
    s_cmp_ge_u32 s34, s33
    s_nop 1
    s_cbranch_scc1 Lback_6
    s_add_u32 s63, s63, 1
    s_cmp_lt_u32 s63, 0x493e0
    s_cbranch_scc1 Lspin_5_l
    s_branch Lback_6
Lspin_7:
    s_mov_b32 s63, 0
Lspin_7_l:
    s_sleep 1
    ds_read_b128 v[26:29], v9 offset:16
    s_waitcnt lgkmcnt(0)
    v_min3_u32 v26, v26, v27, v28
    v_min_u32 v26, v26, v29
    s_nop 0
    v_readfirstlane_b32 s34, v26
    s_nop 1
    s_cmp_ge_u32 s34, s33
    s_nop 1
    s_cbranch_scc1 Lback_8
    s_add_u32 s63, s63, 1
    s_cmp_lt_u32 s63, 0x493e0
    s_cbranch_scc1 Lspin_7_l
    s_branch Lback_8
Lspin_11:
    s_mov_b32 s63, 0
Lspin_11_l:
    s_sleep 1
    ds_read_b128 v[26:29], v9 offset:16
    s_waitcnt lgkmcnt(0)
    v_min3_u32 v26, v26, v27, v28
    v_min_u32 v26, v26, v29
    s_nop 0
    v_readfirstlane_b32 s34, v26
    s_nop 1
    s_cmp_ge_u32 s34, s33
    s_nop 1
    s_cbranch_scc1 Lback_12
    s_add_u32 s63, s63, 1
    s_cmp_lt_u32 s63, 0x493e0
    s_cbranch_scc1 Lspin_11_l
    s_branch Lback_12
Lspin_13:
    s_mov_b32 s63, 0
Lspin_13_l:
    s_sleep 1
    ds_read_b128 v[26:29], v9 offset:16
    s_waitcnt lgkmcnt(0)
    v_min3_u32 v26, v26, v27, v28
    v_min_u32 v26, v26, v29
    s_nop 0
    v_readfirstlane_b32 s34, v26
    s_nop 1
    s_cmp_ge_u32 s34, s33
    s_nop 1
    s_cbranch_scc1 Lback_14
    s_add_u32 s63, s63, 1
    s_cmp_lt_u32 s63, 0x493e0
    s_cbranch_scc1 Lspin_13_l
    s_branch Lback_14
Lspin_16:
    s_mov_b32 s63, 0
Lspin_16_l:
    s_sleep 1
    ds_read_b128 v[26:29], v9 offset:16
    s_waitcnt lgkmcnt(0)
    v_min3_u32 v26, v26, v27, v28
    v_min_u32 v26, v26, v29
    s_nop 0
    v_readfirstlane_b32 s34, v26
    s_nop 1
    s_cmp_ge_u32 s34, s33
    s_nop 1
    s_cbranch_scc1 Lback_17
    s_add_u32 s63, s63, 1
    s_cmp_lt_u32 s63, 0x493e0
    s_cbranch_scc1 Lspin_16_l
    s_branch Lback_17
Lspin_18:
    s_mov_b32 s63, 0
Lspin_18_l:
    s_sleep 1
    ds_read_b128 v[14:17], v9 offset:48
    s_waitcnt lgkmcnt(0)
    v_min3_u32 v14, v14, v15, v16
    v_min_u32 v14, v14, v17
    s_nop 0
    v_readfirstlane_b32 s34, v14
    s_nop 1
    s_cmp_ge_u32 s34, s30
    s_nop 1
    s_cbranch_scc1 Lback_19
    s_add_u32 s63, s63, 1
    s_cmp_lt_u32 s63, 0x493e0
    s_cbranch_scc1 Lspin_18_l
    s_branch Lback_19
Lp_start:
    s_setprio 3
    s_sub_u32 s27, s3, 4
    v_lshlrev_b32 v1, 4, v0
    s_lshl_b32 s59, s6, 4
    s_lshl_b32 s60, s5, 2
    s_add_u32 s59, s59, s60
    s_lshl_b32 s59, s59, 17
    s_add_u32 s38, s38, s59
    s_addc_u32 s39, s39, 0
    s_add_u32 s40, s40, s59
    s_addc_u32 s41, s41, 0
    s_mov_b32 s8, s38
    s_and_b32 s9, s39, 0xffff
    s_mov_b32 s10, 0x80000
    s_mov_b32 s11, 0x20000
    s_mov_b32 s12, s40
    s_and_b32 s13, s41, 0xffff
    s_mov_b32 s14, 0x80000
    s_mov_b32 s15, 0x20000
    v_lshrrev_b32 v250, 4, v0
    v_and_b32 v248, 15, v0
    s_lshl_b32 s59, s27, 12
    v_lshl_add_u32 v249, v250, 8, s59
    v_add_u32 v251, 0, v250
    v_xor_b32 v251, v251, v248
    v_lshl_add_u32 v2, v251, 4, v249
    v_add_u32 v251, 4, v250
    v_xor_b32 v251, v251, v248
    v_lshl_add_u32 v3, v251, 4, v249
    v_add_u32 v251, 8, v250
    v_xor_b32 v251, v251, v248
    v_lshl_add_u32 v4, v251, 4, v249
    v_add_u32 v251, 12, v250
    v_xor_b32 v251, v251, v248
    v_lshl_add_u32 v5, v251, 4, v249
    v_lshlrev_b32 v251, 2, v250
    v_xor_b32 v251, v251, v248
    v_lshl_add_u32 v6, v251, 4, v249
    v_add_u32 v7, s59, v1
    v_mov_b32 v244, 0x24000
    v_mov_b32 v245, 0
    v_mov_b32 v246, 0
    v_add_u32 v247, 0x1c000, v1
    s_lshl_b32 s60, s27, 2
    s_add_u32 s60, s60, 0x24010
    v_mov_b32 v0, s60
    s_mov_b32 s26, 0
    s_mov_b32 s66, 0
    s_mov_b32 s67, 0
    s_mov_b32 s48, 0
    s_and_b32 s79, s6, 3
    s_lshl_b32 s71, s79, 17
    s_add_u32 s72, s71, 0x4000
    s_add_u32 s71, s71, 0x8000
    s_add_u32 s73, s79, 1
    s_and_b32 s73, s73, 3
    s_lshl_b32 s73, s73, 15
    s_add_u32 s75, s59, 0x1c000
    s_add_u32 s74, s59, 0
    s_mov_b32 s69, 5
    s_mov_b32 s76, 5
Lp_qw:
    ds_read_b32 v248, v244 offset:72
    s_waitcnt lgkmcnt(0)
    v_readfirstlane_b32 s64, v248
    s_nop 1
    s_cmp_ge_u32 s64, 4
    s_nop 1
    s_cbranch_scc1 Lp_qgo
    s_sleep 1
    s_add_u32 s67, s67, 1
    s_cmp_lt_u32 s67, 0x249f00
    s_cbranch_scc1 Lp_qw
Lp_qgo:
    s_mov_b32 s67, 0
    s_waitcnt vmcnt(22)
    v_add_u32 v245, 5, v245
    s_mov_b64 exec, 1
    ds_write_b32 v0, v245
    s_mov_b64 exec, -1
    s_mov_b32 m0, s74
    s_bitcmp1_b32 s76, 1
    s_cbranch_scc0 Ltv_21
    buffer_load_dwordx4 v2, s[8:11], s71 offen nt lds
    buffer_load_dwordx4 v3, s[8:11], s71 offen offset:1024 nt lds
    buffer_load_dwordx4 v4, s[8:11], s71 offen offset:2048 nt lds
    buffer_load_dwordx4 v5, s[8:11], s71 offen offset:3072 nt lds
    s_add_u32 s71, s71, 0x4000
    s_and_b32 s71, s71, 0x7ffff
    s_branch Ltd_22
Ltv_21:
    buffer_load_dwordx4 v6, s[12:15], s72 offen nt lds
    buffer_load_dwordx4 v6, s[12:15], s72 offen offset:1024 nt lds
    buffer_load_dwordx4 v6, s[12:15], s72 offen offset:2048 nt lds
    buffer_load_dwordx4 v6, s[12:15], s72 offen offset:3072 nt lds
    s_add_u32 s72, s72, 0x4000
    s_and_b32 s72, s72, 0x7ffff
Ltd_22:
    s_add_u32 s74, s74, 0x4000
    s_cmp_ge_u32 s74, s75
    s_cselect_b32 s64, 0x1c000, 0
    s_sub_u32 s74, s74, s64
    s_add_u32 s76, s76, 1
    s_cmp_eq_u32 s76, 18
    s_cselect_b32 s76, 0, s76
    s_add_u32 s69, s69, 1
    s_mov_b32 m0, s74
    s_bitcmp1_b32 s76, 1
    s_cbranch_scc0 Ltv_24
    buffer_load_dwordx4 v2, s[8:11], s71 offen nt lds
    buffer_load_dwordx4 v3, s[8:11], s71 offen offset:1024 nt lds
    buffer_load_dwordx4 v4, s[8:11], s71 offen offset:2048 nt lds
    buffer_load_dwordx4 v5, s[8:11], s71 offen offset:3072 nt lds
    s_add_u32 s71, s71, 0x4000
    s_and_b32 s71, s71, 0x7ffff
    s_branch Ltd_25
Ltv_24:
    buffer_load_dwordx4 v6, s[12:15], s72 offen nt lds
    buffer_load_dwordx4 v6, s[12:15], s72 offen offset:1024 nt lds
    buffer_load_dwordx4 v6, s[12:15], s72 offen offset:2048 nt lds
    buffer_load_dwordx4 v6, s[12:15], s72 offen offset:3072 nt lds
    s_add_u32 s72, s72, 0x4000
    s_and_b32 s72, s72, 0x7ffff
Ltd_25:
    s_add_u32 s74, s74, 0x4000
    s_cmp_ge_u32 s74, s75
    s_cselect_b32 s64, 0x1c000, 0
    s_sub_u32 s74, s74, s64
    s_add_u32 s76, s76, 1
    s_cmp_eq_u32 s76, 18
    s_cselect_b32 s76, 0, s76
    s_add_u32 s69, s69, 1
    s_mov_b32 s66, 2
    s_waitcnt vmcnt(8)
    v_mov_b32 v249, 1
    s_mov_b64 exec, 1
    ds_add_rtn_u32 v248, v244, v249 offset:76
    s_mov_b64 exec, -1
    s_waitcnt lgkmcnt(0)
    v_readfirstlane_b32 s64, v248
    s_nop 1
    s_cmp_lg_u32 s64, 7
    s_nop 1
    s_cbranch_scc1 Lsg_26
    s_lshl_b32 s64, s4, 5
    s_lshl_b32 s65, s5, 3
    s_add_u32 s64, s64, s65
    s_lshr_b32 s65, s6, 2
    s_add_u32 s64, s64, s65
    s_lshl_b32 s64, s64, 2
    v_mov_b32 v248, s64
    s_lshl_b32 s64, s4, 2
    s_add_u32 s64, s64, s5
    s_lshl_b32 s64, s64, 2
    v_mov_b32 v250, s64
    v_mov_b32 v251, 0x10000
    s_mov_b64 exec, 1
    global_atomic_add v248, v249, s[54:55]
    global_atomic_add v250, v251, s[54:55]
    s_mov_b64 exec, -1
Lsg_26:
    s_lshl_b32 s59, s4, 2
    s_add_u32 s59, s59, s27
    s_lshl_b32 s59, s59, 4
    s_lshl_b32 s60, s5, 2
    s_add_u32 s59, s59, s60
    s_mul_i32 s59, s59, 0x14000
    s_add_u32 s59, s59, 0
    s_add_u32 s60, s56, s59
    s_addc_u32 s61, s57, 0
    s_mov_b32 s28, s60
    s_and_b32 s29, s61, 0xffff
    s_mov_b32 s30, 0x50000
    s_mov_b32 s31, 0x20000
    s_mul_i32 s59, s7, 0x48000
    s_add_u32 s59, s59, 0x2a00000
    s_add_u32 s60, s56, s59
    s_addc_u32 s61, s57, 0
    s_mov_b32 s20, s60
    s_and_b32 s21, s61, 0xffff
    s_mov_b32 s22, 0x48000
    s_mov_b32 s23, 0x20000
    s_mov_b32 s32, s52
    s_and_b32 s33, s53, 0xffff
    s_mov_b32 s34, 0x480000
    s_mov_b32 s35, 0x20000
    s_and_b32 s70, s27, 1
    s_and_b32 s77, s6, 3
    s_mul_i32 s77, s77, 4
    s_add_u32 s77, s77, 18
    v_mov_b32 v8, 0
    v_mov_b32 v9, 0
    v_mov_b32 v10, 0
    v_mov_b32 v11, 0
    v_mov_b32 v12, 0
    v_mov_b32 v13, 0
    v_mov_b32 v14, 0
    v_mov_b32 v15, 0
    v_mov_b32 v16, 0
    v_mov_b32 v17, 0
    v_mov_b32 v18, 0
    v_mov_b32 v19, 0
    v_mov_b32 v20, 0
    v_mov_b32 v21, 0
    v_mov_b32 v22, 0
    v_mov_b32 v23, 0
    v_mov_b32 v24, 0
    v_mov_b32 v25, 0
    v_mov_b32 v26, 0
    v_mov_b32 v27, 0
    v_mov_b32 v28, 0
    v_mov_b32 v29, 0
    v_mov_b32 v30, 0
    v_mov_b32 v31, 0
    v_mov_b32 v32, 0
    v_mov_b32 v33, 0
    v_mov_b32 v34, 0
    v_mov_b32 v35, 0
    v_mov_b32 v36, 0
    v_mov_b32 v37, 0
    v_mov_b32 v38, 0
    v_mov_b32 v39, 0
    v_mov_b32 v40, 0
    v_mov_b32 v41, 0
    v_mov_b32 v42, 0
    v_mov_b32 v43, 0
    v_mov_b32 v44, 0
    v_mov_b32 v45, 0
    v_mov_b32 v46, 0
    v_mov_b32 v47, 0
    v_mov_b32 v48, 0
    v_mov_b32 v49, 0
    v_mov_b32 v50, 0
    v_mov_b32 v51, 0
    v_mov_b32 v52, 0
    v_mov_b32 v53, 0
    v_mov_b32 v54, 0
    v_mov_b32 v55, 0
    v_mov_b32 v56, 0
    v_mov_b32 v57, 0
    v_mov_b32 v58, 0
    v_mov_b32 v59, 0
    v_mov_b32 v60, 0
    v_mov_b32 v61, 0
    v_mov_b32 v62, 0
    v_mov_b32 v63, 0
    v_mov_b32 v64, 0
    v_mov_b32 v65, 0
    v_mov_b32 v66, 0
    v_mov_b32 v67, 0
    v_mov_b32 v68, 0
    v_mov_b32 v69, 0
    v_mov_b32 v70, 0
    v_mov_b32 v71, 0
    v_mov_b32 v72, 0
    v_mov_b32 v73, 0
    v_mov_b32 v74, 0
    v_mov_b32 v75, 0
    v_mov_b32 v76, 0
    v_mov_b32 v77, 0
    v_mov_b32 v78, 0
    v_mov_b32 v79, 0
    v_mov_b32 v80, 0
    v_mov_b32 v81, 0
    v_mov_b32 v82, 0
    v_mov_b32 v83, 0
    v_mov_b32 v84, 0
    v_mov_b32 v85, 0
    v_mov_b32 v86, 0
    v_mov_b32 v87, 0
    v_mov_b32 v88, 0
    v_mov_b32 v89, 0
    v_mov_b32 v90, 0
    v_mov_b32 v91, 0
    v_mov_b32 v92, 0
    v_mov_b32 v93, 0
    v_mov_b32 v94, 0
    v_mov_b32 v95, 0
    v_mov_b32 v96, 0
    v_mov_b32 v97, 0
    v_mov_b32 v98, 0
    v_mov_b32 v99, 0
    v_mov_b32 v100, 0
    v_mov_b32 v101, 0
    v_mov_b32 v102, 0
    v_mov_b32 v103, 0
    v_mov_b32 v104, 0
    v_mov_b32 v105, 0
    v_mov_b32 v106, 0
    v_mov_b32 v107, 0
    v_mov_b32 v108, 0
    v_mov_b32 v109, 0
    v_mov_b32 v110, 0
    v_mov_b32 v111, 0
    v_mov_b32 v112, 0
    v_mov_b32 v113, 0
    v_mov_b32 v114, 0
    v_mov_b32 v115, 0
    v_mov_b32 v116, 0
    v_mov_b32 v117, 0
    v_mov_b32 v118, 0
    v_mov_b32 v119, 0
    v_mov_b32 v120, 0
    v_mov_b32 v121, 0
    v_mov_b32 v122, 0
    v_mov_b32 v123, 0
    v_mov_b32 v124, 0
    v_mov_b32 v125, 0
    v_mov_b32 v126, 0
    v_mov_b32 v127, 0
    v_mov_b32 v128, 0
    v_mov_b32 v129, 0
    v_mov_b32 v130, 0
    v_mov_b32 v131, 0
    v_mov_b32 v132, 0
    v_mov_b32 v133, 0
    v_mov_b32 v134, 0
    v_mov_b32 v135, 0
    v_mov_b32 v136, 0
    v_mov_b32 v137, 0
    v_mov_b32 v138, 0
    v_mov_b32 v139, 0
    v_mov_b32 v140, 0
    v_mov_b32 v141, 0
    v_mov_b32 v142, 0
    v_mov_b32 v143, 0
    v_mov_b32 v144, 0
    v_mov_b32 v145, 0
    v_mov_b32 v146, 0
    v_mov_b32 v147, 0
    v_mov_b32 v148, 0
    v_mov_b32 v149, 0
    v_mov_b32 v150, 0
    v_mov_b32 v151, 0
    s_nop 1
Lp_loop:
    s_cmp_lt_u32 s66, 3
    s_cbranch_scc1 Lp_chk
    s_cmp_lg_u32 s66, 3
    s_cbranch_scc1 Lr_30
    s_waitcnt vmcnt(8)
    s_branch Lrd_27
Lr_30:
    s_cmp_lg_u32 s66, 2
    s_cbranch_scc1 Lr_29
    s_waitcnt vmcnt(4)
    s_branch Lrd_27
Lr_29:
    s_waitcnt vmcnt(0)
Lrd_27:
    v_add_u32 v245, 1, v245
    s_mov_b64 exec, 1
    ds_write_b32 v0, v245
    s_mov_b64 exec, -1
    s_sub_u32 s66, s66, 1
Lp_chk:
    ds_read_b128 v[248:251], v244
    ds_read_b128 v[252:255], v244 offset:32
    s_waitcnt lgkmcnt(0)
    v_min3_u32 v248, v248, v249, v250
    v_min_u32 v248, v248, v251
    s_nop 0
    v_readfirstlane_b32 s78, v248
    v_min3_u32 v252, v252, v253, v254
    v_min_u32 v252, v252, v255
    s_nop 0
    v_readfirstlane_b32 s65, v252
    s_nop 1
    s_cmp_le_u32 s65, s26
    s_nop 1
    s_cbranch_scc1 Lp_tile
    s_min_u32 s64, s77, 0x48
    s_cmp_ge_u32 s78, s64
    s_cbranch_scc1 Lp_y
Lp_tile:
    s_cmp_ge_u32 s69, 0x48
    s_cbranch_scc1 Lp_nospace
    s_add_u32 s64, s78, 7
    s_cmp_ge_u32 s69, s64
    s_cbranch_scc1 Lp_nospace
    s_cmp_ge_u32 s76, 2
    s_cbranch_scc1 Ltk_31
    s_cmp_lg_u32 s48, 0
    s_cbranch_scc1 Ltq_34
    s_lshl_b32 s64, s4, 5
    s_lshl_b32 s65, s5, 3
    s_add_u32 s64, s64, s65
    s_lshr_b32 s65, s6, 2
    s_add_u32 s64, s64, s65
    s_lshl_b32 s64, s64, 2
    v_mov_b32 v248, s64
    s_nop 1
Ltp_35:
    global_load_dword v249, v248, s[54:55] sc1
    s_waitcnt vmcnt(0)
    v_readfirstlane_b32 s64, v249
    s_nop 1
    s_and_b32 s64, s64, 0xff
    s_add_u32 s48, s48, 1
    s_cmp_ge_u32 s64, 4
    s_cbranch_scc1 Ltq_34
    s_sleep 8
    s_cmp_lt_u32 s48, 0x493e0
    s_cbranch_scc1 Ltp_35
Ltq_34:
    s_mov_b32 m0, s74
    s_nop 0
    buffer_load_dwordx4 v7, s[16:19], s73 offen sc1 lds
    buffer_load_dwordx4 v7, s[16:19], s73 offen offset:1024 sc1 lds
    buffer_load_dwordx4 v7, s[16:19], s73 offen offset:2048 sc1 lds
    buffer_load_dwordx4 v7, s[16:19], s73 offen offset:3072 sc1 lds
    s_add_u32 s73, s73, 0x4000
    s_and_b32 s73, s73, 0x1ffff
    s_branch Ltd_33
Ltk_31:
    s_mov_b32 m0, s74
    s_bitcmp1_b32 s76, 1
    s_cbranch_scc0 Ltv_32
    buffer_load_dwordx4 v2, s[8:11], s71 offen nt lds
    buffer_load_dwordx4 v3, s[8:11], s71 offen offset:1024 nt lds
    buffer_load_dwordx4 v4, s[8:11], s71 offen offset:2048 nt lds
    buffer_load_dwordx4 v5, s[8:11], s71 offen offset:3072 nt lds
    s_add_u32 s71, s71, 0x4000
    s_and_b32 s71, s71, 0x7ffff
    s_branch Ltd_33
Ltv_32:
    buffer_load_dwordx4 v6, s[12:15], s72 offen nt lds
    buffer_load_dwordx4 v6, s[12:15], s72 offen offset:1024 nt lds
    buffer_load_dwordx4 v6, s[12:15], s72 offen offset:2048 nt lds
    buffer_load_dwordx4 v6, s[12:15], s72 offen offset:3072 nt lds
    s_add_u32 s72, s72, 0x4000
    s_and_b32 s72, s72, 0x7ffff
Ltd_33:
    s_add_u32 s74, s74, 0x4000
    s_cmp_ge_u32 s74, s75
    s_cselect_b32 s64, 0x1c000, 0
    s_sub_u32 s74, s74, s64
    s_add_u32 s76, s76, 1
    s_cmp_eq_u32 s76, 18
    s_cselect_b32 s76, 0, s76
    s_add_u32 s69, s69, 1
    s_add_u32 s66, s66, 1
    s_branch Lp_loop
Lp_nospace:
    s_cmp_eq_u32 s66, 0
    s_cbranch_scc1 Lp_nap
    s_cmp_lg_u32 s66, 3
    s_cbranch_scc1 Lr_39
    s_waitcnt vmcnt(8)
    s_branch Lrd_36
Lr_39:
    s_cmp_lg_u32 s66, 2
    s_cbranch_scc1 Lr_38
    s_waitcnt vmcnt(4)
    s_branch Lrd_36
Lr_38:
    s_waitcnt vmcnt(0)
Lrd_36:
    v_add_u32 v245, 1, v245
    s_mov_b64 exec, 1
    ds_write_b32 v0, v245
    s_mov_b64 exec, -1
    s_sub_u32 s66, s66, 1
    s_branch Lp_loop
Lp_nap:
    s_add_u32 s67, s67, 1
    s_cmp_ge_u32 s67, 0x124f80
    s_cbranch_scc1 Lp_fin
    s_sleep 1
    s_branch Lp_loop
Lp_y:
    s_cmp_eq_u32 s66, 0
    s_cbranch_scc1 Lp_y2
    s_cmp_lg_u32 s66, 3
    s_cbranch_scc1 Lr_43
    s_waitcnt vmcnt(8)
    s_branch Lrd_40
Lr_43:
    s_cmp_lg_u32 s66, 2
    s_cbranch_scc1 Lr_42
    s_waitcnt vmcnt(4)
    s_branch Lrd_40
Lr_42:
    s_waitcnt vmcnt(0)
Lrd_40:
    v_add_u32 v245, 1, v245
    s_mov_b64 exec, 1
    ds_write_b32 v0, v245
    s_mov_b64 exec, -1
    s_sub_u32 s66, s66, 1
    s_branch Lp_y
Lp_y2:
    s_cmp_lg_u32 s26, 0
    s_cbranch_scc1 Lp_y3
    s_lshl_b32 s64, s4, 4
    v_mov_b32 v252, s64
    s_mov_b32 s68, 0
    s_nop 0
Lp_wp:
    global_load_dwordx4 v[248:251], v252, s[54:55] sc1
    s_waitcnt vmcnt(0)
    v_bfe_u32 v248, v248, 16, 8
    v_bfe_u32 v249, v249, 16, 8
    v_bfe_u32 v250, v250, 16, 8
    v_bfe_u32 v251, v251, 16, 8
    v_min3_u32 v248, v248, v249, v250
    v_min_u32 v248, v248, v251
    s_nop 0
    v_readfirstlane_b32 s64, v248
    s_nop 1
    s_cmp_ge_u32 s64, 32
    s_nop 1
    s_cbranch_scc1 Lp_y3
    s_sleep 8
    s_add_u32 s68, s68, 1
    s_cmp_lt_u32 s68, 0x493e0
    s_cbranch_scc1 Lp_wp
Lp_y3:
    s_add_u32 s62, s26, s79
    s_and_b32 s62, s62, 3
    s_mul_i32 s62, s62, 0x14000
    buffer_load_dwordx4 v[168:171], v1, s[28:31], s62 offen sc1
    buffer_load_dwordx4 v[172:175], v1, s[28:31], s62 offen offset:1024 sc1
    buffer_load_dwordx4 v[176:179], v1, s[28:31], s62 offen offset:2048 sc1
    buffer_load_dwordx4 v[180:183], v1, s[28:31], s62 offen offset:3072 sc1
    s_add_u32 s62, s62, 0x1000
    buffer_load_dwordx4 v[184:187], v1, s[28:31], s62 offen sc1
    buffer_load_dwordx4 v[188:191], v1, s[28:31], s62 offen offset:1024 sc1
    buffer_load_dwordx4 v[192:195], v1, s[28:31], s62 offen offset:2048 sc1
    buffer_load_dwordx4 v[196:199], v1, s[28:31], s62 offen offset:3072 sc1
    s_add_u32 s62, s62, 0x1000
    buffer_load_dwordx4 v[200:203], v1, s[28:31], s62 offen sc1
    buffer_load_dwordx4 v[204:207], v1, s[28:31], s62 offen offset:1024 sc1
    buffer_load_dwordx4 v[208:211], v1, s[28:31], s62 offen offset:2048 sc1
    buffer_load_dwordx4 v[212:215], v1, s[28:31], s62 offen offset:3072 sc1
    s_add_u32 s62, s62, 0x1000
    buffer_load_dwordx4 v[216:219], v1, s[28:31], s62 offen sc1
    buffer_load_dwordx4 v[220:223], v1, s[28:31], s62 offen offset:1024 sc1
    buffer_load_dwordx4 v[224:227], v1, s[28:31], s62 offen offset:2048 sc1
    buffer_load_dwordx4 v[228:231], v1, s[28:31], s62 offen offset:3072 sc1
    s_add_u32 s62, s62, 0x1000
    buffer_load_dwordx4 v[232:235], v1, s[28:31], s62 offen sc1
    buffer_load_dwordx4 v[236:239], v1, s[28:31], s62 offen offset:1024 sc1
    buffer_load_dwordx4 v[240:243], v1, s[28:31], s62 offen offset:2048 sc1
    ds_read_b128 v[152:155], v247
    ds_read_b128 v[156:159], v247 offset:1024
    ds_read_b128 v[160:163], v247 offset:2048
    ds_read_b128 v[164:167], v247 offset:3072
    s_waitcnt lgkmcnt(2)
    s_waitcnt vmcnt(18)
    v_mfma_f32_32x32x16_bf16 v[8:23], v[168:171], v[152:155], v[8:23]
    v_mfma_f32_32x32x16_bf16 v[24:39], v[168:171], v[156:159], v[24:39]
    buffer_load_dwordx4 v[168:171], v1, s[28:31], s62 offen offset:3072 sc1
    s_add_u32 s62, s62, 0x1000
    s_waitcnt vmcnt(18)
    v_mfma_f32_32x32x16_bf16 v[40:55], v[172:175], v[152:155], v[40:55]
    v_mfma_f32_32x32x16_bf16 v[56:71], v[172:175], v[156:159], v[56:71]
    buffer_load_dwordx4 v[172:175], v1, s[28:31], s62 offen sc1
    s_waitcnt vmcnt(18)
    v_mfma_f32_32x32x16_bf16 v[72:87], v[176:179], v[152:155], v[72:87]
    v_mfma_f32_32x32x16_bf16 v[88:103], v[176:179], v[156:159], v[88:103]
    buffer_load_dwordx4 v[176:179], v1, s[28:31], s62 offen offset:1024 sc1
    s_waitcnt vmcnt(18)
    v_mfma_f32_32x32x16_bf16 v[104:119], v[180:183], v[152:155], v[104:119]
    v_mfma_f32_32x32x16_bf16 v[120:135], v[180:183], v[156:159], v[120:135]
    buffer_load_dwordx4 v[180:183], v1, s[28:31], s62 offen offset:2048 sc1
    s_waitcnt vmcnt(18)
    s_cmp_lg_u32 s70, 0
    s_cbranch_scc1 Lsh_44
    v_mfma_f32_32x32x16_bf16 v[136:151], v[184:187], v[152:155], v[136:151]
    s_branch Lsh_45
Lsh_44:
    v_mfma_f32_32x32x16_bf16 v[136:151], v[184:187], v[156:159], v[136:151]
Lsh_45:
    buffer_load_dwordx4 v[184:187], v1, s[28:31], s62 offen offset:3072 sc1
    s_add_u32 s62, s62, 0x1000
    ds_read_b128 v[152:155], v247 offset:4096
    ds_read_b128 v[156:159], v247 offset:5120
    s_waitcnt lgkmcnt(2)
    s_waitcnt vmcnt(18)
    v_mfma_f32_32x32x16_bf16 v[8:23], v[188:191], v[160:163], v[8:23]
    v_mfma_f32_32x32x16_bf16 v[24:39], v[188:191], v[164:167], v[24:39]
    buffer_load_dwordx4 v[188:191], v1, s[28:31], s62 offen sc1
    s_waitcnt vmcnt(18)
    v_mfma_f32_32x32x16_bf16 v[40:55], v[192:195], v[160:163], v[40:55]
    v_mfma_f32_32x32x16_bf16 v[56:71], v[192:195], v[164:167], v[56:71]
    buffer_load_dwordx4 v[192:195], v1, s[28:31], s62 offen offset:1024 sc1
    s_waitcnt vmcnt(18)
    v_mfma_f32_32x32x16_bf16 v[72:87], v[196:199], v[160:163], v[72:87]
    v_mfma_f32_32x32x16_bf16 v[88:103], v[196:199], v[164:167], v[88:103]
    buffer_load_dwordx4 v[196:199], v1, s[28:31], s62 offen offset:2048 sc1
    s_waitcnt vmcnt(18)
    v_mfma_f32_32x32x16_bf16 v[104:119], v[200:203], v[160:163], v[104:119]
    v_mfma_f32_32x32x16_bf16 v[120:135], v[200:203], v[164:167], v[120:135]
    buffer_load_dwordx4 v[200:203], v1, s[28:31], s62 offen offset:3072 sc1
    s_add_u32 s62, s62, 0x1000
    s_waitcnt vmcnt(18)
    s_cmp_lg_u32 s70, 0
    s_cbranch_scc1 Lsh_46
    v_mfma_f32_32x32x16_bf16 v[136:151], v[204:207], v[160:163], v[136:151]
    s_branch Lsh_47
Lsh_46:
    v_mfma_f32_32x32x16_bf16 v[136:151], v[204:207], v[164:167], v[136:151]
Lsh_47:
    buffer_load_dwordx4 v[204:207], v1, s[28:31], s62 offen sc1
    ds_read_b128 v[160:163], v247 offset:6144
    ds_read_b128 v[164:167], v247 offset:7168
    s_waitcnt lgkmcnt(2)
    s_waitcnt vmcnt(18)
    v_mfma_f32_32x32x16_bf16 v[8:23], v[208:211], v[152:155], v[8:23]
    v_mfma_f32_32x32x16_bf16 v[24:39], v[208:211], v[156:159], v[24:39]
    buffer_load_dwordx4 v[208:211], v1, s[28:31], s62 offen offset:1024 sc1
    s_waitcnt vmcnt(18)
    v_mfma_f32_32x32x16_bf16 v[40:55], v[212:215], v[152:155], v[40:55]
    v_mfma_f32_32x32x16_bf16 v[56:71], v[212:215], v[156:159], v[56:71]
    buffer_load_dwordx4 v[212:215], v1, s[28:31], s62 offen offset:2048 sc1
    s_waitcnt vmcnt(18)
    v_mfma_f32_32x32x16_bf16 v[72:87], v[216:219], v[152:155], v[72:87]
    v_mfma_f32_32x32x16_bf16 v[88:103], v[216:219], v[156:159], v[88:103]
    buffer_load_dwordx4 v[216:219], v1, s[28:31], s62 offen offset:3072 sc1
    s_add_u32 s62, s62, 0x1000
    s_waitcnt vmcnt(18)
    v_mfma_f32_32x32x16_bf16 v[104:119], v[220:223], v[152:155], v[104:119]
    v_mfma_f32_32x32x16_bf16 v[120:135], v[220:223], v[156:159], v[120:135]
    buffer_load_dwordx4 v[220:223], v1, s[28:31], s62 offen sc1
    s_waitcnt vmcnt(18)
    s_cmp_lg_u32 s70, 0
    s_cbranch_scc1 Lsh_48
    v_mfma_f32_32x32x16_bf16 v[136:151], v[224:227], v[152:155], v[136:151]
    s_branch Lsh_49
Lsh_48:
    v_mfma_f32_32x32x16_bf16 v[136:151], v[224:227], v[156:159], v[136:151]
Lsh_49:
    buffer_load_dwordx4 v[224:227], v1, s[28:31], s62 offen offset:1024 sc1
    ds_read_b128 v[152:155], v247 offset:8192
    ds_read_b128 v[156:159], v247 offset:9216
    s_waitcnt lgkmcnt(2)
    s_waitcnt vmcnt(18)
    v_mfma_f32_32x32x16_bf16 v[8:23], v[228:231], v[160:163], v[8:23]
    v_mfma_f32_32x32x16_bf16 v[24:39], v[228:231], v[164:167], v[24:39]
    buffer_load_dwordx4 v[228:231], v1, s[28:31], s62 offen offset:2048 sc1
    s_waitcnt vmcnt(18)
    v_mfma_f32_32x32x16_bf16 v[40:55], v[232:235], v[160:163], v[40:55]
    v_mfma_f32_32x32x16_bf16 v[56:71], v[232:235], v[164:167], v[56:71]
    buffer_load_dwordx4 v[232:235], v1, s[28:31], s62 offen offset:3072 sc1
    s_add_u32 s62, s62, 0x1000
    s_waitcnt vmcnt(18)
    v_mfma_f32_32x32x16_bf16 v[72:87], v[236:239], v[160:163], v[72:87]
    v_mfma_f32_32x32x16_bf16 v[88:103], v[236:239], v[164:167], v[88:103]
    buffer_load_dwordx4 v[236:239], v1, s[28:31], s62 offen sc1
    s_waitcnt vmcnt(18)
    v_mfma_f32_32x32x16_bf16 v[104:119], v[240:243], v[160:163], v[104:119]
    v_mfma_f32_32x32x16_bf16 v[120:135], v[240:243], v[164:167], v[120:135]
    buffer_load_dwordx4 v[240:243], v1, s[28:31], s62 offen offset:1024 sc1
    s_waitcnt vmcnt(18)
    s_cmp_lg_u32 s70, 0
    s_cbranch_scc1 Lsh_50
    v_mfma_f32_32x32x16_bf16 v[136:151], v[168:171], v[160:163], v[136:151]
    s_branch Lsh_51
Lsh_50:
    v_mfma_f32_32x32x16_bf16 v[136:151], v[168:171], v[164:167], v[136:151]
Lsh_51:
    buffer_load_dwordx4 v[168:171], v1, s[28:31], s62 offen offset:2048 sc1
    ds_read_b128 v[160:163], v247 offset:10240
    ds_read_b128 v[164:167], v247 offset:11264
    s_waitcnt lgkmcnt(2)
    s_waitcnt vmcnt(18)
    v_mfma_f32_32x32x16_bf16 v[8:23], v[172:175], v[152:155], v[8:23]
    v_mfma_f32_32x32x16_bf16 v[24:39], v[172:175], v[156:159], v[24:39]
    buffer_load_dwordx4 v[172:175], v1, s[28:31], s62 offen offset:3072 sc1
    s_add_u32 s62, s62, 0x1000
    s_waitcnt vmcnt(18)
    v_mfma_f32_32x32x16_bf16 v[40:55], v[176:179], v[152:155], v[40:55]
    v_mfma_f32_32x32x16_bf16 v[56:71], v[176:179], v[156:159], v[56:71]
    buffer_load_dwordx4 v[176:179], v1, s[28:31], s62 offen sc1
    s_waitcnt vmcnt(18)
    v_mfma_f32_32x32x16_bf16 v[72:87], v[180:183], v[152:155], v[72:87]
    v_mfma_f32_32x32x16_bf16 v[88:103], v[180:183], v[156:159], v[88:103]
    buffer_load_dwordx4 v[180:183], v1, s[28:31], s62 offen offset:1024 sc1
    s_waitcnt vmcnt(18)
    v_mfma_f32_32x32x16_bf16 v[104:119], v[184:187], v[152:155], v[104:119]
    v_mfma_f32_32x32x16_bf16 v[120:135], v[184:187], v[156:159], v[120:135]
    buffer_load_dwordx4 v[184:187], v1, s[28:31], s62 offen offset:2048 sc1
    s_waitcnt vmcnt(18)
    s_cmp_lg_u32 s70, 0
    s_cbranch_scc1 Lsh_52
    v_mfma_f32_32x32x16_bf16 v[136:151], v[188:191], v[152:155], v[136:151]
    s_branch Lsh_53
Lsh_52:
    v_mfma_f32_32x32x16_bf16 v[136:151], v[188:191], v[156:159], v[136:151]
Lsh_53:
    buffer_load_dwordx4 v[188:191], v1, s[28:31], s62 offen offset:3072 sc1
    s_add_u32 s62, s62, 0x1000
    ds_read_b128 v[152:155], v247 offset:12288
    ds_read_b128 v[156:159], v247 offset:13312
    s_waitcnt lgkmcnt(2)
    s_waitcnt vmcnt(18)
    v_mfma_f32_32x32x16_bf16 v[8:23], v[192:195], v[160:163], v[8:23]
    v_mfma_f32_32x32x16_bf16 v[24:39], v[192:195], v[164:167], v[24:39]
    buffer_load_dwordx4 v[192:195], v1, s[28:31], s62 offen sc1
    s_waitcnt vmcnt(18)
    v_mfma_f32_32x32x16_bf16 v[40:55], v[196:199], v[160:163], v[40:55]
    v_mfma_f32_32x32x16_bf16 v[56:71], v[196:199], v[164:167], v[56:71]
    buffer_load_dwordx4 v[196:199], v1, s[28:31], s62 offen offset:1024 sc1
    s_waitcnt vmcnt(18)
    v_mfma_f32_32x32x16_bf16 v[72:87], v[200:203], v[160:163], v[72:87]
    v_mfma_f32_32x32x16_bf16 v[88:103], v[200:203], v[164:167], v[88:103]
    buffer_load_dwordx4 v[200:203], v1, s[28:31], s62 offen offset:2048 sc1
    s_waitcnt vmcnt(18)
    v_mfma_f32_32x32x16_bf16 v[104:119], v[204:207], v[160:163], v[104:119]
    v_mfma_f32_32x32x16_bf16 v[120:135], v[204:207], v[164:167], v[120:135]
    buffer_load_dwordx4 v[204:207], v1, s[28:31], s62 offen offset:3072 sc1
    s_add_u32 s62, s62, 0x1000
    s_waitcnt vmcnt(18)
    s_cmp_lg_u32 s70, 0
    s_cbranch_scc1 Lsh_54
    v_mfma_f32_32x32x16_bf16 v[136:151], v[208:211], v[160:163], v[136:151]
    s_branch Lsh_55
Lsh_54:
    v_mfma_f32_32x32x16_bf16 v[136:151], v[208:211], v[164:167], v[136:151]
Lsh_55:
    buffer_load_dwordx4 v[208:211], v1, s[28:31], s62 offen sc1
    ds_read_b128 v[160:163], v247 offset:14336
    ds_read_b128 v[164:167], v247 offset:15360
    s_waitcnt lgkmcnt(2)
    s_waitcnt vmcnt(18)
    v_mfma_f32_32x32x16_bf16 v[8:23], v[212:215], v[152:155], v[8:23]
    v_mfma_f32_32x32x16_bf16 v[24:39], v[212:215], v[156:159], v[24:39]
    buffer_load_dwordx4 v[212:215], v1, s[28:31], s62 offen offset:1024 sc1
    s_waitcnt vmcnt(18)
    v_mfma_f32_32x32x16_bf16 v[40:55], v[216:219], v[152:155], v[40:55]
    v_mfma_f32_32x32x16_bf16 v[56:71], v[216:219], v[156:159], v[56:71]
    buffer_load_dwordx4 v[216:219], v1, s[28:31], s62 offen offset:2048 sc1
    s_waitcnt vmcnt(18)
    v_mfma_f32_32x32x16_bf16 v[72:87], v[220:223], v[152:155], v[72:87]
    v_mfma_f32_32x32x16_bf16 v[88:103], v[220:223], v[156:159], v[88:103]
    buffer_load_dwordx4 v[220:223], v1, s[28:31], s62 offen offset:3072 sc1
    s_add_u32 s62, s62, 0x1000
    s_waitcnt vmcnt(18)
    v_mfma_f32_32x32x16_bf16 v[104:119], v[224:227], v[152:155], v[104:119]
    v_mfma_f32_32x32x16_bf16 v[120:135], v[224:227], v[156:159], v[120:135]
    buffer_load_dwordx4 v[224:227], v1, s[28:31], s62 offen sc1
    s_waitcnt vmcnt(18)
    s_cmp_lg_u32 s70, 0
    s_cbranch_scc1 Lsh_56
    v_mfma_f32_32x32x16_bf16 v[136:151], v[228:231], v[152:155], v[136:151]
    s_branch Lsh_57
Lsh_56:
    v_mfma_f32_32x32x16_bf16 v[136:151], v[228:231], v[156:159], v[136:151]
Lsh_57:
    buffer_load_dwordx4 v[228:231], v1, s[28:31], s62 offen offset:1024 sc1
    ds_read_b128 v[152:155], v247 offset:16384
    ds_read_b128 v[156:159], v247 offset:17408
    s_waitcnt lgkmcnt(2)
    s_waitcnt vmcnt(18)
    v_mfma_f32_32x32x16_bf16 v[8:23], v[232:235], v[160:163], v[8:23]
    v_mfma_f32_32x32x16_bf16 v[24:39], v[232:235], v[164:167], v[24:39]
    buffer_load_dwordx4 v[232:235], v1, s[28:31], s62 offen offset:2048 sc1
    s_waitcnt vmcnt(18)
    v_mfma_f32_32x32x16_bf16 v[40:55], v[236:239], v[160:163], v[40:55]
    v_mfma_f32_32x32x16_bf16 v[56:71], v[236:239], v[164:167], v[56:71]
    buffer_load_dwordx4 v[236:239], v1, s[28:31], s62 offen offset:3072 sc1
    s_add_u32 s62, s62, 0x1000
    s_waitcnt vmcnt(18)
    v_mfma_f32_32x32x16_bf16 v[72:87], v[240:243], v[160:163], v[72:87]
    v_mfma_f32_32x32x16_bf16 v[88:103], v[240:243], v[164:167], v[88:103]
    buffer_load_dwordx4 v[240:243], v1, s[28:31], s62 offen sc1
    s_waitcnt vmcnt(18)
    v_mfma_f32_32x32x16_bf16 v[104:119], v[168:171], v[160:163], v[104:119]
    v_mfma_f32_32x32x16_bf16 v[120:135], v[168:171], v[164:167], v[120:135]
    buffer_load_dwordx4 v[168:171], v1, s[28:31], s62 offen offset:1024 sc1
    s_waitcnt vmcnt(18)
    s_cmp_lg_u32 s70, 0
    s_cbranch_scc1 Lsh_58
    v_mfma_f32_32x32x16_bf16 v[136:151], v[172:175], v[160:163], v[136:151]
    s_branch Lsh_59
Lsh_58:
    v_mfma_f32_32x32x16_bf16 v[136:151], v[172:175], v[164:167], v[136:151]
Lsh_59:
    buffer_load_dwordx4 v[172:175], v1, s[28:31], s62 offen offset:2048 sc1
    ds_read_b128 v[160:163], v247 offset:18432
    ds_read_b128 v[164:167], v247 offset:19456
    s_waitcnt lgkmcnt(2)
    s_waitcnt vmcnt(18)
    v_mfma_f32_32x32x16_bf16 v[8:23], v[176:179], v[152:155], v[8:23]
    v_mfma_f32_32x32x16_bf16 v[24:39], v[176:179], v[156:159], v[24:39]
    buffer_load_dwordx4 v[176:179], v1, s[28:31], s62 offen offset:3072 sc1
    s_add_u32 s62, s62, 0x1000
    s_waitcnt vmcnt(18)
    v_mfma_f32_32x32x16_bf16 v[40:55], v[180:183], v[152:155], v[40:55]
    v_mfma_f32_32x32x16_bf16 v[56:71], v[180:183], v[156:159], v[56:71]
    buffer_load_dwordx4 v[180:183], v1, s[28:31], s62 offen sc1
    s_waitcnt vmcnt(18)
    v_mfma_f32_32x32x16_bf16 v[72:87], v[184:187], v[152:155], v[72:87]
    v_mfma_f32_32x32x16_bf16 v[88:103], v[184:187], v[156:159], v[88:103]
    buffer_load_dwordx4 v[184:187], v1, s[28:31], s62 offen offset:1024 sc1
    s_waitcnt vmcnt(18)
    v_mfma_f32_32x32x16_bf16 v[104:119], v[188:191], v[152:155], v[104:119]
    v_mfma_f32_32x32x16_bf16 v[120:135], v[188:191], v[156:159], v[120:135]
    buffer_load_dwordx4 v[188:191], v1, s[28:31], s62 offen offset:2048 sc1
    s_waitcnt vmcnt(18)
    s_cmp_lg_u32 s70, 0
    s_cbranch_scc1 Lsh_60
    v_mfma_f32_32x32x16_bf16 v[136:151], v[192:195], v[152:155], v[136:151]
    s_branch Lsh_61
Lsh_60:
    v_mfma_f32_32x32x16_bf16 v[136:151], v[192:195], v[156:159], v[136:151]
Lsh_61:
    buffer_load_dwordx4 v[192:195], v1, s[28:31], s62 offen offset:3072 sc1
    s_add_u32 s62, s62, 0x1000
    ds_read_b128 v[152:155], v247 offset:20480
    ds_read_b128 v[156:159], v247 offset:21504
    s_waitcnt lgkmcnt(2)
    s_waitcnt vmcnt(18)
    v_mfma_f32_32x32x16_bf16 v[8:23], v[196:199], v[160:163], v[8:23]
    v_mfma_f32_32x32x16_bf16 v[24:39], v[196:199], v[164:167], v[24:39]
    buffer_load_dwordx4 v[196:199], v1, s[28:31], s62 offen sc1
    s_waitcnt vmcnt(18)
    v_mfma_f32_32x32x16_bf16 v[40:55], v[200:203], v[160:163], v[40:55]
    v_mfma_f32_32x32x16_bf16 v[56:71], v[200:203], v[164:167], v[56:71]
    buffer_load_dwordx4 v[200:203], v1, s[28:31], s62 offen offset:1024 sc1
    s_waitcnt vmcnt(18)
    v_mfma_f32_32x32x16_bf16 v[72:87], v[204:207], v[160:163], v[72:87]
    v_mfma_f32_32x32x16_bf16 v[88:103], v[204:207], v[164:167], v[88:103]
    buffer_load_dwordx4 v[204:207], v1, s[28:31], s62 offen offset:2048 sc1
    s_waitcnt vmcnt(18)
    v_mfma_f32_32x32x16_bf16 v[104:119], v[208:211], v[160:163], v[104:119]
    v_mfma_f32_32x32x16_bf16 v[120:135], v[208:211], v[164:167], v[120:135]
    buffer_load_dwordx4 v[208:211], v1, s[28:31], s62 offen offset:3072 sc1
    s_add_u32 s62, s62, 0x1000
    s_waitcnt vmcnt(18)
    s_cmp_lg_u32 s70, 0
    s_cbranch_scc1 Lsh_62
    v_mfma_f32_32x32x16_bf16 v[136:151], v[212:215], v[160:163], v[136:151]
    s_branch Lsh_63
Lsh_62:
    v_mfma_f32_32x32x16_bf16 v[136:151], v[212:215], v[164:167], v[136:151]
Lsh_63:
    buffer_load_dwordx4 v[212:215], v1, s[28:31], s62 offen sc1
    ds_read_b128 v[160:163], v247 offset:22528
    ds_read_b128 v[164:167], v247 offset:23552
    s_waitcnt lgkmcnt(2)
    s_waitcnt vmcnt(18)
    v_mfma_f32_32x32x16_bf16 v[8:23], v[216:219], v[152:155], v[8:23]
    v_mfma_f32_32x32x16_bf16 v[24:39], v[216:219], v[156:159], v[24:39]
    buffer_load_dwordx4 v[216:219], v1, s[28:31], s62 offen offset:1024 sc1
    s_waitcnt vmcnt(18)
    v_mfma_f32_32x32x16_bf16 v[40:55], v[220:223], v[152:155], v[40:55]
    v_mfma_f32_32x32x16_bf16 v[56:71], v[220:223], v[156:159], v[56:71]
    buffer_load_dwordx4 v[220:223], v1, s[28:31], s62 offen offset:2048 sc1
    s_waitcnt vmcnt(18)
    v_mfma_f32_32x32x16_bf16 v[72:87], v[224:227], v[152:155], v[72:87]
    v_mfma_f32_32x32x16_bf16 v[88:103], v[224:227], v[156:159], v[88:103]
    buffer_load_dwordx4 v[224:227], v1, s[28:31], s62 offen offset:3072 sc1
    s_add_u32 s62, s62, 0x1000
    s_waitcnt vmcnt(18)
    v_mfma_f32_32x32x16_bf16 v[104:119], v[228:231], v[152:155], v[104:119]
    v_mfma_f32_32x32x16_bf16 v[120:135], v[228:231], v[156:159], v[120:135]
    buffer_load_dwordx4 v[228:231], v1, s[28:31], s62 offen sc1
    s_waitcnt vmcnt(18)
    s_cmp_lg_u32 s70, 0
    s_cbranch_scc1 Lsh_64
    v_mfma_f32_32x32x16_bf16 v[136:151], v[232:235], v[152:155], v[136:151]
    s_branch Lsh_65
Lsh_64:
    v_mfma_f32_32x32x16_bf16 v[136:151], v[232:235], v[156:159], v[136:151]
Lsh_65:
    buffer_load_dwordx4 v[232:235], v1, s[28:31], s62 offen offset:1024 sc1
    ds_read_b128 v[152:155], v247 offset:24576
    ds_read_b128 v[156:159], v247 offset:25600
    s_waitcnt lgkmcnt(2)
    s_waitcnt vmcnt(18)
    v_mfma_f32_32x32x16_bf16 v[8:23], v[236:239], v[160:163], v[8:23]
    v_mfma_f32_32x32x16_bf16 v[24:39], v[236:239], v[164:167], v[24:39]
    buffer_load_dwordx4 v[236:239], v1, s[28:31], s62 offen offset:2048 sc1
    s_waitcnt vmcnt(18)
    v_mfma_f32_32x32x16_bf16 v[40:55], v[240:243], v[160:163], v[40:55]
    v_mfma_f32_32x32x16_bf16 v[56:71], v[240:243], v[164:167], v[56:71]
    buffer_load_dwordx4 v[240:243], v1, s[28:31], s62 offen offset:3072 sc1
    s_add_u32 s62, s62, 0x1000
    s_waitcnt vmcnt(18)
    v_mfma_f32_32x32x16_bf16 v[72:87], v[168:171], v[160:163], v[72:87]
    v_mfma_f32_32x32x16_bf16 v[88:103], v[168:171], v[164:167], v[88:103]
    buffer_load_dwordx4 v[168:171], v1, s[28:31], s62 offen sc1
    s_waitcnt vmcnt(18)
    v_mfma_f32_32x32x16_bf16 v[104:119], v[172:175], v[160:163], v[104:119]
    v_mfma_f32_32x32x16_bf16 v[120:135], v[172:175], v[164:167], v[120:135]
    buffer_load_dwordx4 v[172:175], v1, s[28:31], s62 offen offset:1024 sc1
    s_waitcnt vmcnt(18)
    s_cmp_lg_u32 s70, 0
    s_cbranch_scc1 Lsh_66
    v_mfma_f32_32x32x16_bf16 v[136:151], v[176:179], v[160:163], v[136:151]
    s_branch Lsh_67
Lsh_66:
    v_mfma_f32_32x32x16_bf16 v[136:151], v[176:179], v[164:167], v[136:151]
Lsh_67:
    buffer_load_dwordx4 v[176:179], v1, s[28:31], s62 offen offset:2048 sc1
    ds_read_b128 v[160:163], v247 offset:26624
    ds_read_b128 v[164:167], v247 offset:27648
    s_waitcnt lgkmcnt(2)
    s_waitcnt vmcnt(18)
    v_mfma_f32_32x32x16_bf16 v[8:23], v[180:183], v[152:155], v[8:23]
    v_mfma_f32_32x32x16_bf16 v[24:39], v[180:183], v[156:159], v[24:39]
    buffer_load_dwordx4 v[180:183], v1, s[28:31], s62 offen offset:3072 sc1
    s_add_u32 s62, s62, 0x1000
    s_waitcnt vmcnt(18)
    v_mfma_f32_32x32x16_bf16 v[40:55], v[184:187], v[152:155], v[40:55]
    v_mfma_f32_32x32x16_bf16 v[56:71], v[184:187], v[156:159], v[56:71]
    s_waitcnt vmcnt(17)
    v_mfma_f32_32x32x16_bf16 v[72:87], v[188:191], v[152:155], v[72:87]
    v_mfma_f32_32x32x16_bf16 v[88:103], v[188:191], v[156:159], v[88:103]
    s_waitcnt vmcnt(16)
    v_mfma_f32_32x32x16_bf16 v[104:119], v[192:195], v[152:155], v[104:119]
    v_mfma_f32_32x32x16_bf16 v[120:135], v[192:195], v[156:159], v[120:135]
    s_waitcnt vmcnt(15)
    s_cmp_lg_u32 s70, 0
    s_cbranch_scc1 Lsh_68
    v_mfma_f32_32x32x16_bf16 v[136:151], v[196:199], v[152:155], v[136:151]
    s_branch Lsh_69
Lsh_68:
    v_mfma_f32_32x32x16_bf16 v[136:151], v[196:199], v[156:159], v[136:151]
Lsh_69:
    ds_read_b128 v[152:155], v247 offset:28672
    ds_read_b128 v[156:159], v247 offset:29696
    s_waitcnt lgkmcnt(2)
    s_waitcnt vmcnt(14)
    v_mfma_f32_32x32x16_bf16 v[8:23], v[200:203], v[160:163], v[8:23]
    v_mfma_f32_32x32x16_bf16 v[24:39], v[200:203], v[164:167], v[24:39]
    s_waitcnt vmcnt(13)
    v_mfma_f32_32x32x16_bf16 v[40:55], v[204:207], v[160:163], v[40:55]
    v_mfma_f32_32x32x16_bf16 v[56:71], v[204:207], v[164:167], v[56:71]
    s_waitcnt vmcnt(12)
    v_mfma_f32_32x32x16_bf16 v[72:87], v[208:211], v[160:163], v[72:87]
    v_mfma_f32_32x32x16_bf16 v[88:103], v[208:211], v[164:167], v[88:103]
    s_waitcnt vmcnt(11)
    v_mfma_f32_32x32x16_bf16 v[104:119], v[212:215], v[160:163], v[104:119]
    v_mfma_f32_32x32x16_bf16 v[120:135], v[212:215], v[164:167], v[120:135]
    s_waitcnt vmcnt(10)
    s_cmp_lg_u32 s70, 0
    s_cbranch_scc1 Lsh_70
    v_mfma_f32_32x32x16_bf16 v[136:151], v[216:219], v[160:163], v[136:151]
    s_branch Lsh_71
Lsh_70:
    v_mfma_f32_32x32x16_bf16 v[136:151], v[216:219], v[164:167], v[136:151]
Lsh_71:
    ds_read_b128 v[160:163], v247 offset:30720
    ds_read_b128 v[164:167], v247 offset:31744
    s_waitcnt lgkmcnt(2)
    s_waitcnt vmcnt(9)
    v_mfma_f32_32x32x16_bf16 v[8:23], v[220:223], v[152:155], v[8:23]
    v_mfma_f32_32x32x16_bf16 v[24:39], v[220:223], v[156:159], v[24:39]
    s_waitcnt vmcnt(8)
    v_mfma_f32_32x32x16_bf16 v[40:55], v[224:227], v[152:155], v[40:55]
    v_mfma_f32_32x32x16_bf16 v[56:71], v[224:227], v[156:159], v[56:71]
    s_waitcnt vmcnt(7)
    v_mfma_f32_32x32x16_bf16 v[72:87], v[228:231], v[152:155], v[72:87]
    v_mfma_f32_32x32x16_bf16 v[88:103], v[228:231], v[156:159], v[88:103]
    s_waitcnt vmcnt(6)
    v_mfma_f32_32x32x16_bf16 v[104:119], v[232:235], v[152:155], v[104:119]
    v_mfma_f32_32x32x16_bf16 v[120:135], v[232:235], v[156:159], v[120:135]
    s_waitcnt vmcnt(5)
    s_cmp_lg_u32 s70, 0
    s_cbranch_scc1 Lsh_72
    v_mfma_f32_32x32x16_bf16 v[136:151], v[236:239], v[152:155], v[136:151]
    s_branch Lsh_73
Lsh_72:
    v_mfma_f32_32x32x16_bf16 v[136:151], v[236:239], v[156:159], v[136:151]
Lsh_73:
    s_waitcnt lgkmcnt(0)
    v_add_u32 v248, 32, v0
    v_add_u32 v246, 1, v246
    s_mov_b64 exec, 1
    ds_write_b32 v248, v246
    s_mov_b64 exec, -1
    s_waitcnt vmcnt(4)
    v_mfma_f32_32x32x16_bf16 v[8:23], v[240:243], v[160:163], v[8:23]
    v_mfma_f32_32x32x16_bf16 v[24:39], v[240:243], v[164:167], v[24:39]
    s_waitcnt vmcnt(3)
    v_mfma_f32_32x32x16_bf16 v[40:55], v[168:171], v[160:163], v[40:55]
    v_mfma_f32_32x32x16_bf16 v[56:71], v[168:171], v[164:167], v[56:71]
    s_waitcnt vmcnt(2)
    v_mfma_f32_32x32x16_bf16 v[72:87], v[172:175], v[160:163], v[72:87]
    v_mfma_f32_32x32x16_bf16 v[88:103], v[172:175], v[164:167], v[88:103]
    s_waitcnt vmcnt(1)
    v_mfma_f32_32x32x16_bf16 v[104:119], v[176:179], v[160:163], v[104:119]
    v_mfma_f32_32x32x16_bf16 v[120:135], v[176:179], v[164:167], v[120:135]
    s_waitcnt vmcnt(0)
    s_cmp_lg_u32 s70, 0
    s_cbranch_scc1 Lsh_74
    v_mfma_f32_32x32x16_bf16 v[136:151], v[180:183], v[160:163], v[136:151]
    s_branch Lsh_75
Lsh_74:
    v_mfma_f32_32x32x16_bf16 v[136:151], v[180:183], v[164:167], v[136:151]
Lsh_75:
    s_add_u32 s26, s26, 1
    s_add_u32 s77, s77, 18
    s_cmp_lt_u32 s26, 4
    s_nop 8
    s_cbranch_scc1 Lp_loop
Lp_fin:
    s_cmp_eq_u32 s27, s5
    s_cbranch_scc1 Lp_own
    s_lshl_b32 s64, s27, 2
    s_add_u32 s64, s64, s5
    s_mul_i32 s62, s64, 0x4800
    v_cvt_pk_bf16_f32 v8, v8, v9
    v_cvt_pk_bf16_f32 v9, v10, v11
    v_cvt_pk_bf16_f32 v10, v12, v13
    v_cvt_pk_bf16_f32 v11, v14, v15
    buffer_store_dwordx4 v[8:11], v1, s[20:23], s62 offen sc1
    v_cvt_pk_bf16_f32 v16, v16, v17
    v_cvt_pk_bf16_f32 v17, v18, v19
    v_cvt_pk_bf16_f32 v18, v20, v21
    v_cvt_pk_bf16_f32 v19, v22, v23
    buffer_store_dwordx4 v[16:19], v1, s[20:23], s62 offen offset:1024 sc1
    v_cvt_pk_bf16_f32 v24, v24, v25
    v_cvt_pk_bf16_f32 v25, v26, v27
    v_cvt_pk_bf16_f32 v26, v28, v29
    v_cvt_pk_bf16_f32 v27, v30, v31
    buffer_store_dwordx4 v[24:27], v1, s[20:23], s62 offen offset:2048 sc1
    v_cvt_pk_bf16_f32 v32, v32, v33
    v_cvt_pk_bf16_f32 v33, v34, v35
    v_cvt_pk_bf16_f32 v34, v36, v37
    v_cvt_pk_bf16_f32 v35, v38, v39
    buffer_store_dwordx4 v[32:35], v1, s[20:23], s62 offen offset:3072 sc1
    s_add_u32 s62, s62, 0x1000
    v_cvt_pk_bf16_f32 v40, v40, v41
    v_cvt_pk_bf16_f32 v41, v42, v43
    v_cvt_pk_bf16_f32 v42, v44, v45
    v_cvt_pk_bf16_f32 v43, v46, v47
    buffer_store_dwordx4 v[40:43], v1, s[20:23], s62 offen sc1
    v_cvt_pk_bf16_f32 v48, v48, v49
    v_cvt_pk_bf16_f32 v49, v50, v51
    v_cvt_pk_bf16_f32 v50, v52, v53
    v_cvt_pk_bf16_f32 v51, v54, v55
    buffer_store_dwordx4 v[48:51], v1, s[20:23], s62 offen offset:1024 sc1
    v_cvt_pk_bf16_f32 v56, v56, v57
    v_cvt_pk_bf16_f32 v57, v58, v59
    v_cvt_pk_bf16_f32 v58, v60, v61
    v_cvt_pk_bf16_f32 v59, v62, v63
    buffer_store_dwordx4 v[56:59], v1, s[20:23], s62 offen offset:2048 sc1
    v_cvt_pk_bf16_f32 v64, v64, v65
    v_cvt_pk_bf16_f32 v65, v66, v67
    v_cvt_pk_bf16_f32 v66, v68, v69
    v_cvt_pk_bf16_f32 v67, v70, v71
    buffer_store_dwordx4 v[64:67], v1, s[20:23], s62 offen offset:3072 sc1
    s_add_u32 s62, s62, 0x1000
    v_cvt_pk_bf16_f32 v72, v72, v73
    v_cvt_pk_bf16_f32 v73, v74, v75
    v_cvt_pk_bf16_f32 v74, v76, v77
    v_cvt_pk_bf16_f32 v75, v78, v79
    buffer_store_dwordx4 v[72:75], v1, s[20:23], s62 offen sc1
    v_cvt_pk_bf16_f32 v80, v80, v81
    v_cvt_pk_bf16_f32 v81, v82, v83
    v_cvt_pk_bf16_f32 v82, v84, v85
    v_cvt_pk_bf16_f32 v83, v86, v87
    buffer_store_dwordx4 v[80:83], v1, s[20:23], s62 offen offset:1024 sc1
    v_cvt_pk_bf16_f32 v88, v88, v89
    v_cvt_pk_bf16_f32 v89, v90, v91
    v_cvt_pk_bf16_f32 v90, v92, v93
    v_cvt_pk_bf16_f32 v91, v94, v95
    buffer_store_dwordx4 v[88:91], v1, s[20:23], s62 offen offset:2048 sc1
    v_cvt_pk_bf16_f32 v96, v96, v97
    v_cvt_pk_bf16_f32 v97, v98, v99
    v_cvt_pk_bf16_f32 v98, v100, v101
    v_cvt_pk_bf16_f32 v99, v102, v103
    buffer_store_dwordx4 v[96:99], v1, s[20:23], s62 offen offset:3072 sc1
    s_add_u32 s62, s62, 0x1000
    v_cvt_pk_bf16_f32 v104, v104, v105
    v_cvt_pk_bf16_f32 v105, v106, v107
    v_cvt_pk_bf16_f32 v106, v108, v109
    v_cvt_pk_bf16_f32 v107, v110, v111
    buffer_store_dwordx4 v[104:107], v1, s[20:23], s62 offen sc1
    v_cvt_pk_bf16_f32 v112, v112, v113
    v_cvt_pk_bf16_f32 v113, v114, v115
    v_cvt_pk_bf16_f32 v114, v116, v117
    v_cvt_pk_bf16_f32 v115, v118, v119
    buffer_store_dwordx4 v[112:115], v1, s[20:23], s62 offen offset:1024 sc1
    v_cvt_pk_bf16_f32 v120, v120, v121
    v_cvt_pk_bf16_f32 v121, v122, v123
    v_cvt_pk_bf16_f32 v122, v124, v125
    v_cvt_pk_bf16_f32 v123, v126, v127
    buffer_store_dwordx4 v[120:123], v1, s[20:23], s62 offen offset:2048 sc1
    v_cvt_pk_bf16_f32 v128, v128, v129
    v_cvt_pk_bf16_f32 v129, v130, v131
    v_cvt_pk_bf16_f32 v130, v132, v133
    v_cvt_pk_bf16_f32 v131, v134, v135
    buffer_store_dwordx4 v[128:131], v1, s[20:23], s62 offen offset:3072 sc1
    s_add_u32 s62, s62, 0x1000
    v_cvt_pk_bf16_f32 v136, v136, v137
    v_cvt_pk_bf16_f32 v137, v138, v139
    v_cvt_pk_bf16_f32 v138, v140, v141
    v_cvt_pk_bf16_f32 v139, v142, v143
    buffer_store_dwordx4 v[136:139], v1, s[20:23], s62 offen sc1
    v_cvt_pk_bf16_f32 v144, v144, v145
    v_cvt_pk_bf16_f32 v145, v146, v147
    v_cvt_pk_bf16_f32 v146, v148, v149
    v_cvt_pk_bf16_f32 v147, v150, v151
    buffer_store_dwordx4 v[144:147], v1, s[20:23], s62 offen offset:1024 sc1
    s_waitcnt vmcnt(0)
    s_nop 0
    s_branch Lp_sent
Lp_own:
    ds_write_b128 v1, v[8:11]
    ds_write_b128 v1, v[12:15] offset:1024
    ds_write_b128 v1, v[16:19] offset:2048
    ds_write_b128 v1, v[20:23] offset:3072
    ds_write_b128 v1, v[24:27] offset:4096
    ds_write_b128 v1, v[28:31] offset:5120
    ds_write_b128 v1, v[32:35] offset:6144
    ds_write_b128 v1, v[36:39] offset:7168
    ds_write_b128 v1, v[40:43] offset:8192
    ds_write_b128 v1, v[44:47] offset:9216
    ds_write_b128 v1, v[48:51] offset:10240
    ds_write_b128 v1, v[52:55] offset:11264
    ds_write_b128 v1, v[56:59] offset:12288
    ds_write_b128 v1, v[60:63] offset:13312
    ds_write_b128 v1, v[64:67] offset:14336
    ds_write_b128 v1, v[68:71] offset:15360
    ds_write_b128 v1, v[72:75] offset:16384
    ds_write_b128 v1, v[76:79] offset:17408
    ds_write_b128 v1, v[80:83] offset:18432
    ds_write_b128 v1, v[84:87] offset:19456
    ds_write_b128 v1, v[88:91] offset:20480
    ds_write_b128 v1, v[92:95] offset:21504
    ds_write_b128 v1, v[96:99] offset:22528
    ds_write_b128 v1, v[100:103] offset:23552
    ds_write_b128 v1, v[104:107] offset:24576
    ds_write_b128 v1, v[108:111] offset:25600
    ds_write_b128 v1, v[112:115] offset:26624
    ds_write_b128 v1, v[116:119] offset:27648
    ds_write_b128 v1, v[120:123] offset:28672
    ds_write_b128 v1, v[124:127] offset:29696
    ds_write_b128 v1, v[128:131] offset:30720
    ds_write_b128 v1, v[132:135] offset:31744
    ds_write_b128 v1, v[136:139] offset:32768
    ds_write_b128 v1, v[140:143] offset:33792
    ds_write_b128 v1, v[144:147] offset:34816
    ds_write_b128 v1, v[148:151] offset:35840
    s_waitcnt lgkmcnt(0)
Lp_sent:
    v_mov_b32 v249, 1
    s_mov_b64 exec, 1
    ds_add_rtn_u32 v248, v244, v249 offset:64
    s_mov_b64 exec, -1
    s_waitcnt lgkmcnt(0)
    v_readfirstlane_b32 s64, v248
    v_mov_b32 v250, 0
    s_nop 0
    s_mov_b32 s66, s64
    s_cmp_lg_u32 s64, 3
    s_nop 0
    s_cbranch_scc1 Lp_xpoll
    s_mov_b64 exec, 1
    global_atomic_add v250, v249, s[24:25]
    s_mov_b64 exec, -1
Lp_xpoll:
    v_bfe_u32 v251, v1, 4, 5
    v_mul_u32_u24 v251, 0x900, v251
    v_lshrrev_b32 v249, 9, v1
    v_lshl_add_u32 v251, v249, 4, v251
    s_mul_i32 s71, s6, 0x24000
    s_mul_i32 s63, s4, 0x480
    s_add_u32 s71, s71, s63
    s_add_u32 s64, s5, 1
    s_lshr_b32 s64, s64, 1
    s_lshl_b32 s65, s5, 2
    s_add_u32 s64, s64, s65
    s_lshl_b32 s72, s64, 6
    s_lshr_b32 s64, s5, 1
    s_mul_i32 s64, s64, 0x240
    s_add_u32 s64, s64, 0x100
    s_and_b32 s65, s5, 1
    s_mul_i32 s65, s65, 0x12000
    s_add_u32 s73, s64, s65
    s_mov_b32 s67, 0
    s_cmp_lg_u32 s66, 3
    s_cbranch_scc1 Lp_xl
Lp_xp:
    global_load_dword v248, v250, s[24:25] sc1
    s_waitcnt vmcnt(0)
    v_readfirstlane_b32 s64, v248
    s_nop 1
    s_cmp_ge_u32 s64, 4
    s_nop 1
    s_cbranch_scc1 Lp_xok
    s_sleep 4
    s_add_u32 s67, s67, 1
    s_cmp_lt_u32 s67, 0x493e0
    s_cbranch_scc1 Lp_xp
Lp_xok:
    v_mov_b32 v248, 1
    s_mov_b64 exec, 1
    ds_write_b32 v244, v248 offset:68
    s_mov_b64 exec, -1
    s_branch Lp_xgo
Lp_xl:
    s_sleep 1
    ds_read_b32 v248, v244 offset:68
    s_waitcnt lgkmcnt(0)
    v_readfirstlane_b32 s64, v248
    s_nop 1
    s_cmp_lg_u32 s64, 0
    s_nop 1
    s_cbranch_scc1 Lp_xgo
    s_add_u32 s67, s67, 1
    s_cmp_lt_u32 s67, 0x249f00
    s_cbranch_scc1 Lp_xl
Lp_xgo:
    s_mul_i32 s62, s5, 0x12000
    s_lshl_b32 s64, s27, 10
    s_add_u32 s62, s62, s64
    s_cmp_eq_u32 s5, 0
    s_cselect_b32 s63, 0x10000000, s62
    buffer_load_dwordx4 v[8:11], v1, s[20:23], s63 offen sc1
    s_add_u32 s63, s63, 0x1000
    buffer_load_dwordx4 v[12:15], v1, s[20:23], s63 offen sc1
    s_add_u32 s63, s63, 0x1000
    buffer_load_dwordx4 v[16:19], v1, s[20:23], s63 offen sc1
    s_add_u32 s63, s63, 0x1000
    buffer_load_dwordx4 v[20:23], v1, s[20:23], s63 offen sc1
    s_add_u32 s63, s63, 0x1000
    buffer_load_dwordx4 v[24:27], v1, s[20:23], s63 offen sc1
    s_add_u32 s63, s63, 0x1000
    s_add_u32 s62, s62, 0x4800
    s_cmp_eq_u32 s5, 1
    s_cselect_b32 s63, 0x10000000, s62
    buffer_load_dwordx4 v[28:31], v1, s[20:23], s63 offen sc1
    s_add_u32 s63, s63, 0x1000
    buffer_load_dwordx4 v[32:35], v1, s[20:23], s63 offen sc1
    s_add_u32 s63, s63, 0x1000
    buffer_load_dwordx4 v[36:39], v1, s[20:23], s63 offen sc1
    s_add_u32 s63, s63, 0x1000
    buffer_load_dwordx4 v[40:43], v1, s[20:23], s63 offen sc1
    s_add_u32 s63, s63, 0x1000
    buffer_load_dwordx4 v[44:47], v1, s[20:23], s63 offen sc1
    s_add_u32 s63, s63, 0x1000
    s_add_u32 s62, s62, 0x4800
    s_cmp_eq_u32 s5, 2
    s_cselect_b32 s63, 0x10000000, s62
    buffer_load_dwordx4 v[48:51], v1, s[20:23], s63 offen sc1
    s_add_u32 s63, s63, 0x1000
    buffer_load_dwordx4 v[52:55], v1, s[20:23], s63 offen sc1
    s_add_u32 s63, s63, 0x1000
    buffer_load_dwordx4 v[56:59], v1, s[20:23], s63 offen sc1
    s_add_u32 s63, s63, 0x1000
    buffer_load_dwordx4 v[60:63], v1, s[20:23], s63 offen sc1
    s_add_u32 s63, s63, 0x1000
    buffer_load_dwordx4 v[64:67], v1, s[20:23], s63 offen sc1
    s_add_u32 s63, s63, 0x1000
    s_add_u32 s62, s62, 0x4800
    s_cmp_eq_u32 s5, 3
    s_cselect_b32 s63, 0x10000000, s62
    buffer_load_dwordx4 v[68:71], v1, s[20:23], s63 offen sc1
    s_add_u32 s63, s63, 0x1000
    buffer_load_dwordx4 v[72:75], v1, s[20:23], s63 offen sc1
    s_add_u32 s63, s63, 0x1000
    buffer_load_dwordx4 v[76:79], v1, s[20:23], s63 offen sc1
    s_add_u32 s63, s63, 0x1000
    buffer_load_dwordx4 v[80:83], v1, s[20:23], s63 offen sc1
    s_add_u32 s63, s63, 0x1000
    buffer_load_dwordx4 v[84:87], v1, s[20:23], s63 offen sc1
    s_add_u32 s63, s63, 0x1000
    s_add_u32 s62, s62, 0x4800
    s_lshl_b32 s64, s27, 11
    v_add_u32 v248, s64, v1
    ds_read_b128 v[88:91], v248
    ds_read_b128 v[92:95], v248 offset:1024
    ds_read_b128 v[96:99], v248 offset:8192
    ds_read_b128 v[100:103], v248 offset:9216
    ds_read_b128 v[104:107], v248 offset:16384
    ds_read_b128 v[108:111], v248 offset:17408
    ds_read_b128 v[112:115], v248 offset:24576
    ds_read_b128 v[116:119], v248 offset:25600
    ds_read_b128 v[120:123], v248 offset:32768
    ds_read_b128 v[124:127], v248 offset:33792
    s_waitcnt vmcnt(0) lgkmcnt(0)
    v_lshlrev_b32 v248, 16, v8
    v_and_b32 v249, 0xffff0000, v8
    v_add_f32 v88, v88, v248
    v_add_f32 v89, v89, v249
    v_lshlrev_b32 v248, 16, v9
    v_and_b32 v249, 0xffff0000, v9
    v_add_f32 v90, v90, v248
    v_add_f32 v91, v91, v249
    v_lshlrev_b32 v248, 16, v10
    v_and_b32 v249, 0xffff0000, v10
    v_add_f32 v92, v92, v248
    v_add_f32 v93, v93, v249
    v_lshlrev_b32 v248, 16, v11
    v_and_b32 v249, 0xffff0000, v11
    v_add_f32 v94, v94, v248
    v_add_f32 v95, v95, v249
    v_lshlrev_b32 v248, 16, v28
    v_and_b32 v249, 0xffff0000, v28
    v_add_f32 v88, v88, v248
    v_add_f32 v89, v89, v249
    v_lshlrev_b32 v248, 16, v29
    v_and_b32 v249, 0xffff0000, v29
    v_add_f32 v90, v90, v248
    v_add_f32 v91, v91, v249
    v_lshlrev_b32 v248, 16, v30
    v_and_b32 v249, 0xffff0000, v30
    v_add_f32 v92, v92, v248
    v_add_f32 v93, v93, v249
    v_lshlrev_b32 v248, 16, v31
    v_and_b32 v249, 0xffff0000, v31
    v_add_f32 v94, v94, v248
    v_add_f32 v95, v95, v249
    v_lshlrev_b32 v248, 16, v48
    v_and_b32 v249, 0xffff0000, v48
    v_add_f32 v88, v88, v248
    v_add_f32 v89, v89, v249
    v_lshlrev_b32 v248, 16, v49
    v_and_b32 v249, 0xffff0000, v49
    v_add_f32 v90, v90, v248
    v_add_f32 v91, v91, v249
    v_lshlrev_b32 v248, 16, v50
    v_and_b32 v249, 0xffff0000, v50
    v_add_f32 v92, v92, v248
    v_add_f32 v93, v93, v249
    v_lshlrev_b32 v248, 16, v51
    v_and_b32 v249, 0xffff0000, v51
    v_add_f32 v94, v94, v248
    v_add_f32 v95, v95, v249
    v_lshlrev_b32 v248, 16, v68
    v_and_b32 v249, 0xffff0000, v68
    v_add_f32 v88, v88, v248
    v_add_f32 v89, v89, v249
    v_lshlrev_b32 v248, 16, v69
    v_and_b32 v249, 0xffff0000, v69
    v_add_f32 v90, v90, v248
    v_add_f32 v91, v91, v249
    v_lshlrev_b32 v248, 16, v70
    v_and_b32 v249, 0xffff0000, v70
    v_add_f32 v92, v92, v248
    v_add_f32 v93, v93, v249
    v_lshlrev_b32 v248, 16, v71
    v_and_b32 v249, 0xffff0000, v71
    v_add_f32 v94, v94, v248
    v_add_f32 v95, v95, v249
    v_cvt_pk_bf16_f32 v88, v88, v89
    v_cvt_pk_bf16_f32 v89, v90, v91
    v_cvt_pk_bf16_f32 v90, v92, v93
    v_cvt_pk_bf16_f32 v91, v94, v95
    s_add_u32 s64, s27, 0
    s_lshr_b32 s65, s64, 2
    s_lshl_b32 s65, s65, 6
    s_add_u32 s65, s65, s72
    s_bfe_u32 s68, s64, 0x10001
    s_mul_i32 s68, s68, 0x12000
    s_add_u32 s65, s65, s68
    s_cmp_ge_u32 s64, 16
    s_cselect_b32 s65, s73, s65
    s_and_b32 s68, s64, 1
    s_lshl_b32 s68, s68, 5
    s_add_u32 s65, s65, s68
    s_add_u32 s65, s65, s71
    s_cmp_ge_u32 s64, 18
    s_cselect_b32 s65, 0x10000000, s65
    buffer_store_dwordx4 v[88:91], v251, s[32:35], s65 offen
    v_lshlrev_b32 v248, 16, v12
    v_and_b32 v249, 0xffff0000, v12
    v_add_f32 v96, v96, v248
    v_add_f32 v97, v97, v249
    v_lshlrev_b32 v248, 16, v13
    v_and_b32 v249, 0xffff0000, v13
    v_add_f32 v98, v98, v248
    v_add_f32 v99, v99, v249
    v_lshlrev_b32 v248, 16, v14
    v_and_b32 v249, 0xffff0000, v14
    v_add_f32 v100, v100, v248
    v_add_f32 v101, v101, v249
    v_lshlrev_b32 v248, 16, v15
    v_and_b32 v249, 0xffff0000, v15
    v_add_f32 v102, v102, v248
    v_add_f32 v103, v103, v249
    v_lshlrev_b32 v248, 16, v32
    v_and_b32 v249, 0xffff0000, v32
    v_add_f32 v96, v96, v248
    v_add_f32 v97, v97, v249
    v_lshlrev_b32 v248, 16, v33
    v_and_b32 v249, 0xffff0000, v33
    v_add_f32 v98, v98, v248
    v_add_f32 v99, v99, v249
    v_lshlrev_b32 v248, 16, v34
    v_and_b32 v249, 0xffff0000, v34
    v_add_f32 v100, v100, v248
    v_add_f32 v101, v101, v249
    v_lshlrev_b32 v248, 16, v35
    v_and_b32 v249, 0xffff0000, v35
    v_add_f32 v102, v102, v248
    v_add_f32 v103, v103, v249
    v_lshlrev_b32 v248, 16, v52
    v_and_b32 v249, 0xffff0000, v52
    v_add_f32 v96, v96, v248
    v_add_f32 v97, v97, v249
    v_lshlrev_b32 v248, 16, v53
    v_and_b32 v249, 0xffff0000, v53
    v_add_f32 v98, v98, v248
    v_add_f32 v99, v99, v249
    v_lshlrev_b32 v248, 16, v54
    v_and_b32 v249, 0xffff0000, v54
    v_add_f32 v100, v100, v248
    v_add_f32 v101, v101, v249
    v_lshlrev_b32 v248, 16, v55
    v_and_b32 v249, 0xffff0000, v55
    v_add_f32 v102, v102, v248
    v_add_f32 v103, v103, v249
    v_lshlrev_b32 v248, 16, v72
    v_and_b32 v249, 0xffff0000, v72
    v_add_f32 v96, v96, v248
    v_add_f32 v97, v97, v249
    v_lshlrev_b32 v248, 16, v73
    v_and_b32 v249, 0xffff0000, v73
    v_add_f32 v98, v98, v248
    v_add_f32 v99, v99, v249
    v_lshlrev_b32 v248, 16, v74
    v_and_b32 v249, 0xffff0000, v74
    v_add_f32 v100, v100, v248
    v_add_f32 v101, v101, v249
    v_lshlrev_b32 v248, 16, v75
    v_and_b32 v249, 0xffff0000, v75
    v_add_f32 v102, v102, v248
    v_add_f32 v103, v103, v249
    v_cvt_pk_bf16_f32 v96, v96, v97
    v_cvt_pk_bf16_f32 v97, v98, v99
    v_cvt_pk_bf16_f32 v98, v100, v101
    v_cvt_pk_bf16_f32 v99, v102, v103
    s_add_u32 s64, s27, 4
    s_lshr_b32 s65, s64, 2
    s_lshl_b32 s65, s65, 6
    s_add_u32 s65, s65, s72
    s_bfe_u32 s68, s64, 0x10001
    s_mul_i32 s68, s68, 0x12000
    s_add_u32 s65, s65, s68
    s_cmp_ge_u32 s64, 16
    s_cselect_b32 s65, s73, s65
    s_and_b32 s68, s64, 1
    s_lshl_b32 s68, s68, 5
    s_add_u32 s65, s65, s68
    s_add_u32 s65, s65, s71
    s_cmp_ge_u32 s64, 18
    s_cselect_b32 s65, 0x10000000, s65
    buffer_store_dwordx4 v[96:99], v251, s[32:35], s65 offen
    v_lshlrev_b32 v248, 16, v16
    v_and_b32 v249, 0xffff0000, v16
    v_add_f32 v104, v104, v248
    v_add_f32 v105, v105, v249
    v_lshlrev_b32 v248, 16, v17
    v_and_b32 v249, 0xffff0000, v17
    v_add_f32 v106, v106, v248
    v_add_f32 v107, v107, v249
    v_lshlrev_b32 v248, 16, v18
    v_and_b32 v249, 0xffff0000, v18
    v_add_f32 v108, v108, v248
    v_add_f32 v109, v109, v249
    v_lshlrev_b32 v248, 16, v19
    v_and_b32 v249, 0xffff0000, v19
    v_add_f32 v110, v110, v248
    v_add_f32 v111, v111, v249
    v_lshlrev_b32 v248, 16, v36
    v_and_b32 v249, 0xffff0000, v36
    v_add_f32 v104, v104, v248
    v_add_f32 v105, v105, v249
    v_lshlrev_b32 v248, 16, v37
    v_and_b32 v249, 0xffff0000, v37
    v_add_f32 v106, v106, v248
    v_add_f32 v107, v107, v249
    v_lshlrev_b32 v248, 16, v38
    v_and_b32 v249, 0xffff0000, v38
    v_add_f32 v108, v108, v248
    v_add_f32 v109, v109, v249
    v_lshlrev_b32 v248, 16, v39
    v_and_b32 v249, 0xffff0000, v39
    v_add_f32 v110, v110, v248
    v_add_f32 v111, v111, v249
    v_lshlrev_b32 v248, 16, v56
    v_and_b32 v249, 0xffff0000, v56
    v_add_f32 v104, v104, v248
    v_add_f32 v105, v105, v249
    v_lshlrev_b32 v248, 16, v57
    v_and_b32 v249, 0xffff0000, v57
    v_add_f32 v106, v106, v248
    v_add_f32 v107, v107, v249
    v_lshlrev_b32 v248, 16, v58
    v_and_b32 v249, 0xffff0000, v58
    v_add_f32 v108, v108, v248
    v_add_f32 v109, v109, v249
    v_lshlrev_b32 v248, 16, v59
    v_and_b32 v249, 0xffff0000, v59
    v_add_f32 v110, v110, v248
    v_add_f32 v111, v111, v249
    v_lshlrev_b32 v248, 16, v76
    v_and_b32 v249, 0xffff0000, v76
    v_add_f32 v104, v104, v248
    v_add_f32 v105, v105, v249
    v_lshlrev_b32 v248, 16, v77
    v_and_b32 v249, 0xffff0000, v77
    v_add_f32 v106, v106, v248
    v_add_f32 v107, v107, v249
    v_lshlrev_b32 v248, 16, v78
    v_and_b32 v249, 0xffff0000, v78
    v_add_f32 v108, v108, v248
    v_add_f32 v109, v109, v249
    v_lshlrev_b32 v248, 16, v79
    v_and_b32 v249, 0xffff0000, v79
    v_add_f32 v110, v110, v248
    v_add_f32 v111, v111, v249
    v_cvt_pk_bf16_f32 v104, v104, v105
    v_cvt_pk_bf16_f32 v105, v106, v107
    v_cvt_pk_bf16_f32 v106, v108, v109
    v_cvt_pk_bf16_f32 v107, v110, v111
    s_add_u32 s64, s27, 8
    s_lshr_b32 s65, s64, 2
    s_lshl_b32 s65, s65, 6
    s_add_u32 s65, s65, s72
    s_bfe_u32 s68, s64, 0x10001
    s_mul_i32 s68, s68, 0x12000
    s_add_u32 s65, s65, s68
    s_cmp_ge_u32 s64, 16
    s_cselect_b32 s65, s73, s65
    s_and_b32 s68, s64, 1
    s_lshl_b32 s68, s68, 5
    s_add_u32 s65, s65, s68
    s_add_u32 s65, s65, s71
    s_cmp_ge_u32 s64, 18
    s_cselect_b32 s65, 0x10000000, s65
    buffer_store_dwordx4 v[104:107], v251, s[32:35], s65 offen
    v_lshlrev_b32 v248, 16, v20
    v_and_b32 v249, 0xffff0000, v20
    v_add_f32 v112, v112, v248
    v_add_f32 v113, v113, v249
    v_lshlrev_b32 v248, 16, v21
    v_and_b32 v249, 0xffff0000, v21
    v_add_f32 v114, v114, v248
    v_add_f32 v115, v115, v249
    v_lshlrev_b32 v248, 16, v22
    v_and_b32 v249, 0xffff0000, v22
    v_add_f32 v116, v116, v248
    v_add_f32 v117, v117, v249
    v_lshlrev_b32 v248, 16, v23
    v_and_b32 v249, 0xffff0000, v23
    v_add_f32 v118, v118, v248
    v_add_f32 v119, v119, v249
    v_lshlrev_b32 v248, 16, v40
    v_and_b32 v249, 0xffff0000, v40
    v_add_f32 v112, v112, v248
    v_add_f32 v113, v113, v249
    v_lshlrev_b32 v248, 16, v41
    v_and_b32 v249, 0xffff0000, v41
    v_add_f32 v114, v114, v248
    v_add_f32 v115, v115, v249
    v_lshlrev_b32 v248, 16, v42
    v_and_b32 v249, 0xffff0000, v42
    v_add_f32 v116, v116, v248
    v_add_f32 v117, v117, v249
    v_lshlrev_b32 v248, 16, v43
    v_and_b32 v249, 0xffff0000, v43
    v_add_f32 v118, v118, v248
    v_add_f32 v119, v119, v249
    v_lshlrev_b32 v248, 16, v60
    v_and_b32 v249, 0xffff0000, v60
    v_add_f32 v112, v112, v248
    v_add_f32 v113, v113, v249
    v_lshlrev_b32 v248, 16, v61
    v_and_b32 v249, 0xffff0000, v61
    v_add_f32 v114, v114, v248
    v_add_f32 v115, v115, v249
    v_lshlrev_b32 v248, 16, v62
    v_and_b32 v249, 0xffff0000, v62
    v_add_f32 v116, v116, v248
    v_add_f32 v117, v117, v249
    v_lshlrev_b32 v248, 16, v63
    v_and_b32 v249, 0xffff0000, v63
    v_add_f32 v118, v118, v248
    v_add_f32 v119, v119, v249
    v_lshlrev_b32 v248, 16, v80
    v_and_b32 v249, 0xffff0000, v80
    v_add_f32 v112, v112, v248
    v_add_f32 v113, v113, v249
    v_lshlrev_b32 v248, 16, v81
    v_and_b32 v249, 0xffff0000, v81
    v_add_f32 v114, v114, v248
    v_add_f32 v115, v115, v249
    v_lshlrev_b32 v248, 16, v82
    v_and_b32 v249, 0xffff0000, v82
    v_add_f32 v116, v116, v248
    v_add_f32 v117, v117, v249
    v_lshlrev_b32 v248, 16, v83
    v_and_b32 v249, 0xffff0000, v83
    v_add_f32 v118, v118, v248
    v_add_f32 v119, v119, v249
    v_cvt_pk_bf16_f32 v112, v112, v113
    v_cvt_pk_bf16_f32 v113, v114, v115
    v_cvt_pk_bf16_f32 v114, v116, v117
    v_cvt_pk_bf16_f32 v115, v118, v119
    s_add_u32 s64, s27, 12
    s_lshr_b32 s65, s64, 2
    s_lshl_b32 s65, s65, 6
    s_add_u32 s65, s65, s72
    s_bfe_u32 s68, s64, 0x10001
    s_mul_i32 s68, s68, 0x12000
    s_add_u32 s65, s65, s68
    s_cmp_ge_u32 s64, 16
    s_cselect_b32 s65, s73, s65
    s_and_b32 s68, s64, 1
    s_lshl_b32 s68, s68, 5
    s_add_u32 s65, s65, s68
    s_add_u32 s65, s65, s71
    s_cmp_ge_u32 s64, 18
    s_cselect_b32 s65, 0x10000000, s65
    buffer_store_dwordx4 v[112:115], v251, s[32:35], s65 offen
    v_lshlrev_b32 v248, 16, v24
    v_and_b32 v249, 0xffff0000, v24
    v_add_f32 v120, v120, v248
    v_add_f32 v121, v121, v249
    v_lshlrev_b32 v248, 16, v25
    v_and_b32 v249, 0xffff0000, v25
    v_add_f32 v122, v122, v248
    v_add_f32 v123, v123, v249
    v_lshlrev_b32 v248, 16, v26
    v_and_b32 v249, 0xffff0000, v26
    v_add_f32 v124, v124, v248
    v_add_f32 v125, v125, v249
    v_lshlrev_b32 v248, 16, v27
    v_and_b32 v249, 0xffff0000, v27
    v_add_f32 v126, v126, v248
    v_add_f32 v127, v127, v249
    v_lshlrev_b32 v248, 16, v44
    v_and_b32 v249, 0xffff0000, v44
    v_add_f32 v120, v120, v248
    v_add_f32 v121, v121, v249
    v_lshlrev_b32 v248, 16, v45
    v_and_b32 v249, 0xffff0000, v45
    v_add_f32 v122, v122, v248
    v_add_f32 v123, v123, v249
    v_lshlrev_b32 v248, 16, v46
    v_and_b32 v249, 0xffff0000, v46
    v_add_f32 v124, v124, v248
    v_add_f32 v125, v125, v249
    v_lshlrev_b32 v248, 16, v47
    v_and_b32 v249, 0xffff0000, v47
    v_add_f32 v126, v126, v248
    v_add_f32 v127, v127, v249
    v_lshlrev_b32 v248, 16, v64
    v_and_b32 v249, 0xffff0000, v64
    v_add_f32 v120, v120, v248
    v_add_f32 v121, v121, v249
    v_lshlrev_b32 v248, 16, v65
    v_and_b32 v249, 0xffff0000, v65
    v_add_f32 v122, v122, v248
    v_add_f32 v123, v123, v249
    v_lshlrev_b32 v248, 16, v66
    v_and_b32 v249, 0xffff0000, v66
    v_add_f32 v124, v124, v248
    v_add_f32 v125, v125, v249
    v_lshlrev_b32 v248, 16, v67
    v_and_b32 v249, 0xffff0000, v67
    v_add_f32 v126, v126, v248
    v_add_f32 v127, v127, v249
    v_lshlrev_b32 v248, 16, v84
    v_and_b32 v249, 0xffff0000, v84
    v_add_f32 v120, v120, v248
    v_add_f32 v121, v121, v249
    v_lshlrev_b32 v248, 16, v85
    v_and_b32 v249, 0xffff0000, v85
    v_add_f32 v122, v122, v248
    v_add_f32 v123, v123, v249
    v_lshlrev_b32 v248, 16, v86
    v_and_b32 v249, 0xffff0000, v86
    v_add_f32 v124, v124, v248
    v_add_f32 v125, v125, v249
    v_lshlrev_b32 v248, 16, v87
    v_and_b32 v249, 0xffff0000, v87
    v_add_f32 v126, v126, v248
    v_add_f32 v127, v127, v249
    v_cvt_pk_bf16_f32 v120, v120, v121
    v_cvt_pk_bf16_f32 v121, v122, v123
    v_cvt_pk_bf16_f32 v122, v124, v125
    v_cvt_pk_bf16_f32 v123, v126, v127
    s_add_u32 s64, s27, 16
    s_lshr_b32 s65, s64, 2
    s_lshl_b32 s65, s65, 6
    s_add_u32 s65, s65, s72
    s_bfe_u32 s68, s64, 0x10001
    s_mul_i32 s68, s68, 0x12000
    s_add_u32 s65, s65, s68
    s_cmp_ge_u32 s64, 16
    s_cselect_b32 s65, s73, s65
    s_and_b32 s68, s64, 1
    s_lshl_b32 s68, s68, 5
    s_add_u32 s65, s65, s68
    s_add_u32 s65, s65, s71
    s_cmp_ge_u32 s64, 18
    s_cselect_b32 s65, 0x10000000, s65
    buffer_store_dwordx4 v[120:123], v251, s[32:35], s65 offen
    s_nop 1
    s_branch Lm_done
Lm_done:
    s_endpgm
.section .rodata,"a"
.p2align 6
.amdhsa_kernel concat_heads__gqa_block_cached__gqa_block_cached__near_ridge_kernel
  .amdhsa_next_free_vgpr 256
  .amdhsa_next_free_sgpr 80
  .amdhsa_accum_offset 256
  .amdhsa_group_segment_fixed_size 0
  .amdhsa_kernarg_size 104
  .amdhsa_user_sgpr_count 2
  .amdhsa_user_sgpr_kernarg_segment_ptr 1
  .amdhsa_system_sgpr_workgroup_id_x 1
.end_amdhsa_kernel
```
